```python
import torch

def _softmax(x, axis=-1):
    return torch.softmax(x, dim=axis)
def _gelu(x):
    return torch.nn.functional.gelu(x, approximate="tanh")
def _silu(x):
    return torch.nn.functional.silu(x)
def _sigmoid(x):
    return torch.sigmoid(x)
def _layernorm(x, axis=-1, eps=1e-5):
    m = x.mean(dim=axis, keepdim=True)
    v = x.var(dim=axis, keepdim=True, unbiased=False)
    return (x - m) / torch.sqrt(v + eps)
def _scatter_add(tgt, idx, src, axis=0):
    return tgt.clone().index_add_(axis, idx, src)
def _segment_sum(src, seg, n):
    out = torch.zeros((n,) + src.shape[1:], dtype=src.dtype)
    return out.index_add_(0, seg, src)
def _pad(x, pw):
    flat = tuple(v for pair in reversed(pw) for v in pair)
    return torch.nn.functional.pad(x, flat)

kernel_name = 'gated_mix__ssm_conv_s4__dense_activation_squared_relu__prompt'

def setup_inputs():

    _w = (lambda a: (lambda t: t.to(torch.bfloat16) if t.is_floating_point() else t)(torch.as_tensor(a)))
    def _A_setup():
        B, L, D, N = 1, 2048, 512, 128
        A_re = -(lambda _x: torch.exp(torch.as_tensor(_x)))((lambda *s: torch.randn(*s, dtype=torch.bfloat16) * 3.2)(D, N))
        A_im = torch.pi * (lambda *s: torch.randn(*s, dtype=torch.bfloat16) * 0.1)(D, N)
        B_re = (lambda *s: torch.randn(*s, dtype=torch.bfloat16) * 0.2)(D, N)
        B_im = (lambda *s: torch.randn(*s, dtype=torch.bfloat16) * 0.2)(D, N)
        C_re = (lambda *s: torch.randn(*s, dtype=torch.bfloat16) * 0.2)(D, N)
        C_im = (lambda *s: torch.randn(*s, dtype=torch.bfloat16) * 0.2)(D, N)
        log_dt = (lambda *s: torch.randn(*s, dtype=torch.bfloat16) * 0.1)(D) * 0.5 - 4.0
        Dskip = (lambda *s: torch.randn(*s, dtype=torch.bfloat16) * 0.1)(D)
        return {
            "u": _w((lambda *s: torch.randn(*s, dtype=torch.bfloat16) * 0.05)(B, L, D)),
            "A_re": _w(A_re),
            "A_im": _w(A_im),
            "B_re": _w(B_re),
            "B_im": _w(B_im),
            "C_re": _w(C_re),
            "C_im": _w(C_im),
            "log_dt": _w(log_dt),
            "Dskip": _w(Dskip),
        }
    _A_in = _A_setup()

    def _B_setup():
        B, S, D, F = 1, 2048, 512, 1376
        return {
            "x": _w((lambda *s: torch.randn(*s, dtype=torch.bfloat16) * 0.05)(B, S, D)),
            "w1": _w((lambda *s: torch.randn(*s, dtype=torch.bfloat16) * 0.05)(D, F)),
            "b1": _w((lambda *s: torch.randn(*s, dtype=torch.bfloat16) * 0.05)(F)),
            "w2": _w((lambda *s: torch.randn(*s, dtype=torch.bfloat16) * 0.05)(F, D)),
            "b2": _w((lambda *s: torch.randn(*s, dtype=torch.bfloat16) * 0.05)(D)),
        }
    _B_in = _B_setup()

    return {
        "A_u": _A_in["u"],
        "A_A_re": _A_in["A_re"],
        "A_A_im": _A_in["A_im"],
        "A_B_re": _A_in["B_re"],
        "A_B_im": _A_in["B_im"],
        "A_C_re": _A_in["C_re"],
        "A_C_im": _A_in["C_im"],
        "A_log_dt": _A_in["log_dt"],
        "A_Dskip": _A_in["Dskip"],
        "B_x": _B_in["x"],
        "B_w1": _B_in["w1"],
        "B_b1": _B_in["b1"],
        "B_w2": _B_in["w2"],
        "B_b2": _B_in["b2"],
        "gate_w": _w((lambda *s: torch.randn(*s, dtype=torch.bfloat16) * 0.05)(512) * 16.0),
    }

def reference(A_u, A_A_re, A_A_im, A_B_re, A_B_im, A_C_re, A_C_im, A_log_dt, A_Dskip, B_x, B_w1, B_b1, B_w2, B_b2, gate_w):
    def _A_ref(u, A_re, A_im, B_re, B_im, C_re, C_im, log_dt, Dskip):
        Bsz, L, D = u.shape
        dt = torch.exp(log_dt)[:, None]
        A = A_re + 1j * A_im
        Bc = B_re + 1j * B_im
        Cc = C_re + 1j * C_im
        logdA = dt * A
        dB = dt * Bc
        l = (lambda x, dt: x.to(dt))(torch.arange(L), A_re.dtype)
        P = torch.exp(logdA[:, :, None] * l[None, None, :])
        K = torch.einsum("dn,dnl,dn->dl", Cc, P, dB).real
        L2 = 2 * L
        Kp = _pad(K, ((0, 0), (0, L)))
        up = (lambda x, *d: x.permute(*d))(u, 0, 2, 1)
        up = _pad(up, ((0, 0), (0, 0), (0, L)))
        Kf = (lambda x, axes=(-2,-1): torch.fft.rfft2(x.float(), dim=axes))(Kp[:, None, :], axes=(-2, -1))
        Uf = (lambda x, axes=(-2,-1): torch.fft.rfft2(x.float(), dim=axes))(up[:, :, None, :], axes=(-2, -1))
        Yf = Uf * Kf[None, :, :, :]
        y = (lambda x, s, axes=(-2,-1): torch.fft.irfft2(x, s=s, dim=axes).to(torch.bfloat16))(Yf, (1, L2), axes=(-2, -1))[:, :, 0, :L]
        y = (lambda x, *d: x.permute(*d))(y, 0, 2, 1) + u * Dskip[None, None, :]
        return y

    def _B_ref(x, w1, b1, w2, b2):
        h = torch.einsum("bsd,df->bsf", x, w1) + b1
        zero = torch.zeros_like(h)
        r = torch.where(h > zero, h, zero)
        h = r * r
        out = torch.einsum("bsf,fd->bsd", h, w2) + b2
        return out

    x = A_u
    g = _sigmoid((x * gate_w).sum(-1, keepdims=True))
    a = _A_ref(x, A_A_re, A_A_im, A_B_re, A_B_im, A_C_re, A_C_im, A_log_dt, A_Dskip)
    b = _B_ref(x, B_w1, B_b1, B_w2, B_b2)
    return g * a + (1 - g) * b
```

```asm
; @launch grid=(256,1,1) block=(768,1,1) lds=163840
.amdgcn_target "amdgcn-amd-amdhsa--gfx950"
.text
.globl gated_mix__ssm_conv_s4__dense_activation_squared_relu__prompt_kernel
.p2align 8
.type gated_mix__ssm_conv_s4__dense_activation_squared_relu__prompt_kernel,@function
gated_mix__ssm_conv_s4__dense_activation_squared_relu__prompt_kernel:
    s_load_dwordx16 s[16:31], s[0:1], 0
    s_load_dwordx16 s[32:47], s[0:1], 64
    s_load_dwordx4 s[48:51], s[0:1], 128
    v_lshrrev_b32 v2, 6, v0
    s_cmpk_ge_u32 s2, 256
    s_cbranch_scc1 L_end
    v_readfirstlane_b32 s3, v2
    s_cmp_ge_u32 s3, 8
    s_cbranch_scc1 L_ssm
    s_cmp_ge_u32 s3, 4
    s_cbranch_scc1 L_cons
    s_cmp_lg_u32 s3, 0
    s_cbranch_scc1 L_disp
    s_getpc_b64 s[8:9]
    s_and_b32 s10, s2, 24
    s_lshl_b32 s10, s10, 10
    v_lshl_add_u32 v1, v0, 7, s10
    global_load_dword v14, v1, s[8:9]
    s_lshl_b32 s10, s2, 9
    v_lshl_add_u32 v2, v0, 4, s10
    s_mov_b32 m0, 131136
    s_mov_b32 exec_hi, 0
    v_lshlrev_b32 v3, 21, v0
    s_waitcnt lgkmcnt(0)
    global_load_lds_dwordx4 v2, s[18:19]
    s_addk_i32 m0, 512
    s_and_b32 s10, s2, 7
    global_load_lds_dwordx4 v2, s[20:21]
    s_addk_i32 m0, 512
    s_lshl_b32 s10, s10, 7
    global_load_lds_dwordx4 v2, s[22:23]
    s_addk_i32 m0, 512
    s_lshr_b32 s12, s2, 3
    global_load_lds_dwordx4 v2, s[24:25]
    s_addk_i32 m0, 704
    s_lshl_b32 s12, s12, 16
    global_load_lds_dwordx4 v2, s[26:27]
    s_addk_i32 m0, 512
    s_add_u32 s10, s10, s12
    global_load_lds_dwordx4 v2, s[28:29]
    s_mov_b32 exec_hi, -1
    v_lshl_add_u32 v1, v0, 10, s10
    global_load_dword v15, v1, s[16:17]
    s_mov_b64 exec, 31
    global_load_dword v16, v3, s[50:51] offset:64
    s_mov_b64 exec, -1
L_disp:
    v_and_b32 v0, 63, v0
    s_mov_b32 s66, 0
    s_cmp_eq_u32 s3, 1
    s_cbranch_scc1 L_ldx
    s_cmp_eq_u32 s3, 2
    s_cbranch_scc1 L_ldw
    s_and_b32 s60, s3, 1
    s_lshr_b32 s59, s2, 3
    s_and_b32 s55, s2, 7
    s_lshl_b32 s10, s59, 16
    s_lshl_b32 s11, s60, 6
    s_add_u32 s10, s10, s11
    s_lshl_b32 s11, s55, 7
    s_add_u32 s10, s10, s11
    v_lshrrev_b32 v12, 3, v0
    v_bfe_u32 v4, v0, 2, 1
    v_lshl_add_u32 v4, v4, 5, v12
    v_and_b32 v11, 3, v0
    v_lshlrev_b32 v5, 4, v11
    v_lshl_add_u32 v4, v4, 10, v5
    v_xor_b32 v5, 16, v4
    v_add_u32 v5, 7168, v5
    v_xor_b32 v6, 32, v4
    v_add_u32 v6, 14336, v6
    v_xor_b32 v7, 48, v4
    v_add_u32 v7, 21504, v7
    s_mul_i32 s11, s60, 4608
    s_add_u32 s58, s11, 152064
    s_mov_b32 m0, s58
    s_waitcnt lgkmcnt(0)
    s_load_dword s62, s[50:51], 0
    s_mov_b32 s4, s16
    s_and_b32 s5, s17, 0xffff
    s_mov_b32 s6, 0x200000
    s_mov_b32 s7, 0x20000
    buffer_load_dwordx4 v4, s[4:7], s10 offen offset:0 lds
    buffer_load_dwordx4 v5, s[4:7], s10 offen offset:1024 lds
    buffer_load_dwordx4 v6, s[4:7], s10 offen offset:2048 lds
    buffer_load_dwordx4 v7, s[4:7], s10 offen offset:3072 lds
    s_barrier
    s_branch L_help2
L_ldx:
    s_getpc_b64 s[92:93]
L_tp_1:
    s_add_u32 s92, s92, L_tab-L_tp_1
    s_addc_u32 s93, s93, 0
    s_bfe_u32 s56, s2, 0x20001
    s_lshl_b32 s56, s56, 2
    s_bfe_u32 s54, s2, 0x20003
    s_add_u32 s56, s56, s54
    v_lshrrev_b32 v1, 3, v0
    v_lshrrev_b32 v2, 4, v0
    v_and_b32 v3, 7, v0
    v_xor_b32 v2, v3, v2
    v_lshlrev_b32 v1, 10, v1
    v_lshl_add_u32 v4, v2, 4, v1
    v_xor_b32 v5, 64, v4
    v_add_u32 v5, 7168, v5
    v_add_u32 v6, 14336, v4
    v_add_u32 v7, 14336, v5
    s_lshl_b32 s10, s56, 17
    s_mov_b32 s96, 0x19120b
    s_mov_b32 s97, 0x19120b04
    s_mov_b32 s94, 163728
    s_mov_b32 s12, 0
    s_mov_b32 s98, 0
    v_mov_b32 v8, 163712
    v_mov_b32 v9, 0
    v_and_b32 v13, 3, v0
    v_lshl_add_u32 v13, v13, 2, v8
    v_add_u32 v13, 32, v13
    s_mov_b32 s6, 0x200000
    s_mov_b32 s7, 0x20000
    s_waitcnt lgkmcnt(0)
    s_mov_b32 s4, s16
    s_and_b32 s5, s17, 0xffff
    s_barrier
    s_lshr_b32 s13, s2, 5
    s_lshl_b32 s13, s13, 7
    v_mov_b32 v3, s13
    s_mov_b64 exec, 1
    global_load_dword v140, v3, s[42:43]
    global_load_dword v141, v3, s[40:41]
    s_and_b32 s14, s2, 7
    s_lshl_b32 s14, s14, 18
    v_add_u32 v3, s14, v3
    global_load_dword v143, v3, s[46:47]
    s_mov_b64 exec, -1
L_x_loop:
    s_and_b32 s13, s96, 0xff
    s_lshl_b32 s13, s13, 12
    s_mov_b32 s14, s10
    s_add_u32 m0, s13, 0
    s_add_u32 s10, s10, 128
    buffer_load_dwordx4 v4, s[4:7], s14 offen offset:0 lds
    buffer_load_dwordx4 v5, s[4:7], s14 offen offset:1024 lds
    buffer_load_dwordx4 v6, s[4:7], s14 offen offset:2048 lds
    buffer_load_dwordx4 v7, s[4:7], s14 offen offset:3072 lds
    s_add_u32 m0, s13, 4096
    s_add_u32 s14, s14, 32768
    buffer_load_dwordx4 v4, s[4:7], s14 offen offset:0 lds
    buffer_load_dwordx4 v5, s[4:7], s14 offen offset:1024 lds
    buffer_load_dwordx4 v6, s[4:7], s14 offen offset:2048 lds
    buffer_load_dwordx4 v7, s[4:7], s14 offen offset:3072 lds
    s_add_u32 m0, s13, 8192
    s_add_u32 s14, s14, 32768
    buffer_load_dwordx4 v4, s[4:7], s14 offen offset:0 lds
    buffer_load_dwordx4 v5, s[4:7], s14 offen offset:1024 lds
    buffer_load_dwordx4 v6, s[4:7], s14 offen offset:2048 lds
    buffer_load_dwordx4 v7, s[4:7], s14 offen offset:3072 lds
    s_add_u32 m0, s13, 12288
    s_add_u32 s14, s14, 32768
    ds_read_b32 v20, v13
    buffer_load_dwordx4 v4, s[4:7], s14 offen offset:0 lds
    buffer_load_dwordx4 v5, s[4:7], s14 offen offset:1024 lds
    buffer_load_dwordx4 v6, s[4:7], s14 offen offset:2048 lds
    buffer_load_dwordx4 v7, s[4:7], s14 offen offset:3072 lds
    v_add_u32 v9, 4, v9
    s_mov_b32 m0, s94
    s_mov_b64 exec, 1
    global_load_lds_dword v9, s[92:93]
    s_mov_b64 exec, -1
    s_add_u32 s12, s12, 1
    s_lshr_b64 s[96:97], s[96:97], 8
    s_cmp_lg_u32 s12, 1
    s_cbranch_scc1 L_x_nh
    v_and_b32 v22, 1, v0
    v_lshl_add_u32 v22, v22, 2, v8
L_x_h_2:
    ds_read_b32 v21, v22 offset:24
    s_add_u32 s66, s66, 0x1000
    s_cbranch_scc1 L_end
    s_waitcnt lgkmcnt(0)
    v_cmp_gt_u32 vcc, 1, v21
    s_cbranch_vccnz L_x_h_2
L_x_nh:
    s_cmp_lt_u32 s12, 5
    s_cbranch_scc1 L_x_loop
    s_cmp_eq_u32 s12, 8
    s_cbranch_scc1 L_w2
    s_sub_u32 s15, s12, 4
    s_waitcnt lgkmcnt(0)
    v_cmp_gt_u32 vcc, s15, v20
    s_cbranch_vccz L_x_f_5
L_x_f_4:
    ds_read_b32 v20, v13
    s_add_u32 s66, s66, 0x1000
    s_cbranch_scc1 L_end
    s_waitcnt lgkmcnt(0)
    v_cmp_gt_u32 vcc, s15, v20
    s_cbranch_vccnz L_x_f_4
L_x_f_5:
    s_branch L_x_loop
L_ldw:
    s_getpc_b64 s[92:93]
L_tp_6:
    s_add_u32 s92, s92, L_tab-L_tp_6
    s_addc_u32 s93, s93, 0
    v_mov_b32 v8, 163712
    v_mov_b32 v9, 0
    v_lshl_add_u32 v3, v0, 2, v8
    s_mov_b32 exec_hi, 0
    ds_write_b32 v3, v9
    s_mov_b64 exec, -1
    s_and_b32 s57, s2, 1
    s_lshl_b32 s57, s57, 3
    s_lshr_b32 s55, s2, 5
    s_add_u32 s57, s57, s55
    v_add_u32 v1, 0, v0
    v_mul_u32_u24 v2, 0xaaab, v1
    v_lshrrev_b32 v24, 19, v2
    v_mul_u32_u24 v2, 2560, v24
    v_lshl_add_u32 v4, v0, 4, v2
    v_add_u32 v1, 64, v0
    v_mul_u32_u24 v2, 0xaaab, v1
    v_lshrrev_b32 v25, 19, v2
    v_mul_u32_u24 v2, 2560, v25
    v_lshl_add_u32 v5, v0, 4, v2
    v_add_u32 v1, 128, v0
    v_mul_u32_u24 v2, 0xaaab, v1
    v_lshrrev_b32 v26, 19, v2
    v_mul_u32_u24 v2, 2560, v26
    v_lshl_add_u32 v6, v0, 4, v2
    v_and_b32 v1, 32, v0
    v_xor_b32 v5, v5, v1
    v_xor_b32 v6, 32, v6
    s_mul_i32 s10, s57, 192
    s_mov_b32 s53, 44032
    v_and_b32 v13, 3, v0
    v_lshl_add_u32 v13, v13, 2, v8
    v_add_u32 v13, 32, v13
    s_mov_b32 s96, 0x1d160f08
    s_mov_b32 s97, s96
    s_mov_b32 s94, 163732
    s_mov_b32 s12, 0
    s_mov_b32 s98, 1
    s_mov_b32 s6, 1409024
    s_mov_b32 s7, 0x20000
    s_waitcnt lgkmcnt(0)
    s_mov_b32 s4, s36
    s_and_b32 s5, s37, 0xffff
    s_cmp_ge_u32 s57, 14
    s_cbranch_scc1 L_ld_gate
L_ld_go:
    s_barrier
    s_mul_i32 s13, s2, 5504
    s_add_u32 s14, s36, s13
    s_addc_u32 s15, s37, 0
    v_lshlrev_b32 v3, 7, v0
    s_movk_i32 exec_hi, 0x7ff
    global_load_dword v140, v3, s[14:15]
    s_mov_b64 exec, -1
L_w_loop:
    s_and_b32 s13, s96, 0xff
    s_lshl_b32 s13, s13, 12
    s_add_u32 m0, s13, 0
    s_nop 0
    buffer_load_dwordx4 v4, s[4:7], s10 offen offset:0 lds
    buffer_load_dwordx4 v5, s[4:7], s10 offen offset:1024 lds
    buffer_load_dwordx4 v6, s[4:7], s10 offen offset:2048 lds
    s_add_u32 s10, s10, s53
    s_add_u32 m0, s13, 3072
    s_nop 0
    buffer_load_dwordx4 v4, s[4:7], s10 offen offset:0 lds
    buffer_load_dwordx4 v5, s[4:7], s10 offen offset:1024 lds
    buffer_load_dwordx4 v6, s[4:7], s10 offen offset:2048 lds
    s_add_u32 s10, s10, s53
    s_add_u32 m0, s13, 6144
    s_nop 0
    buffer_load_dwordx4 v4, s[4:7], s10 offen offset:0 lds
    buffer_load_dwordx4 v5, s[4:7], s10 offen offset:1024 lds
    buffer_load_dwordx4 v6, s[4:7], s10 offen offset:2048 lds
    s_add_u32 s10, s10, s53
    s_add_u32 m0, s13, 9216
    ds_read_b32 v20, v13
    buffer_load_dwordx4 v4, s[4:7], s10 offen offset:0 lds
    buffer_load_dwordx4 v5, s[4:7], s10 offen offset:1024 lds
    buffer_load_dwordx4 v6, s[4:7], s10 offen offset:2048 lds
    s_add_u32 s10, s10, s53
    v_add_u32 v9, 4, v9
    s_mov_b32 m0, s94
    s_mov_b64 exec, 1
    global_load_lds_dword v9, s[92:93]
    s_mov_b64 exec, -1
    s_add_u32 s12, s12, 1
    s_lshr_b64 s[96:97], s[96:97], 8
    s_cmp_lg_u32 s12, 1
    s_cbranch_scc1 L_w_nh
    v_and_b32 v22, 1, v0
    v_lshl_add_u32 v22, v22, 2, v8
L_w_h_7:
    ds_read_b32 v21, v22 offset:24
    s_add_u32 s66, s66, 0x1000
    s_cbranch_scc1 L_end
    s_waitcnt lgkmcnt(0)
    v_cmp_gt_u32 vcc, 1, v21
    s_cbranch_vccnz L_w_h_7
L_w_nh:
    s_cmp_lt_u32 s12, 4
    s_cbranch_scc1 L_w_loop
    s_cmp_eq_u32 s12, 8
    s_cbranch_scc1 L_w2
    s_sub_u32 s15, s12, 3
    s_waitcnt lgkmcnt(0)
    v_cmp_gt_u32 vcc, s15, v20
    s_cbranch_vccz L_w_f_10
L_w_f_9:
    ds_read_b32 v20, v13
    s_add_u32 s66, s66, 0x1000
    s_cbranch_scc1 L_end
    s_waitcnt lgkmcnt(0)
    v_cmp_gt_u32 vcc, s15, v20
    s_cbranch_vccnz L_w_f_9
L_w_f_10:
    s_branch L_w_loop
L_ld_gate:
    v_mov_b32 v15, 0x80000000
    s_cmp_eq_u32 s57, 15
    s_cbranch_scc1 L_ld_gate2
    v_add_u32 v1, 0, v0
    v_mul_u32_u24 v2, 12, v24
    v_sub_u32 v1, v1, v2
    v_cmp_gt_u32 vcc, 4, v1
    s_nop 1
    v_cndmask_b32 v4, v15, v4, vcc
    v_add_u32 v1, 64, v0
    v_mul_u32_u24 v2, 12, v25
    v_sub_u32 v1, v1, v2
    v_cmp_gt_u32 vcc, 4, v1
    s_nop 1
    v_cndmask_b32 v5, v15, v5, vcc
    v_add_u32 v1, 128, v0
    v_mul_u32_u24 v2, 12, v26
    v_sub_u32 v1, v1, v2
    v_cmp_gt_u32 vcc, 4, v1
    s_nop 1
    v_cndmask_b32 v6, v15, v6, vcc
    s_branch L_ld_go
L_ld_gate2:
    s_sub_u32 s4, s44, 2048
    s_subb_u32 s5, s45, 0
    s_and_b32 s5, s5, 0xffff
    s_mov_b32 s6, 3072
    s_mov_b32 s53, 32
    s_mov_b32 s10, 0
    v_add_u32 v1, 0, v0
    v_mul_u32_u24 v2, 12, v24
    v_sub_u32 v1, v1, v2
    v_lshrrev_b32 v2, 3, v24
    v_xor_b32 v2, v2, v24
    v_and_b32 v2, 1, v2
    v_lshlrev_b32 v2, 1, v2
    v_cmp_eq_u32 vcc, v1, v2
    v_and_b32 v2, 14, v24
    v_lshlrev_b32 v2, 1, v2
    v_add_u32 v2, 2048, v2
    v_cndmask_b32 v4, v15, v2, vcc
    v_add_u32 v1, 64, v0
    v_mul_u32_u24 v2, 12, v25
    v_sub_u32 v1, v1, v2
    v_lshrrev_b32 v2, 3, v25
    v_xor_b32 v2, v2, v25
    v_and_b32 v2, 1, v2
    v_lshlrev_b32 v2, 1, v2
    v_cmp_eq_u32 vcc, v1, v2
    v_and_b32 v2, 14, v25
    v_lshlrev_b32 v2, 1, v2
    v_add_u32 v2, 1024, v2
    v_cndmask_b32 v5, v15, v2, vcc
    v_add_u32 v1, 128, v0
    v_mul_u32_u24 v2, 12, v26
    v_sub_u32 v1, v1, v2
    v_lshrrev_b32 v2, 3, v26
    v_xor_b32 v2, v2, v26
    v_and_b32 v2, 1, v2
    v_lshlrev_b32 v2, 1, v2
    v_cmp_eq_u32 vcc, v1, v2
    v_and_b32 v2, 14, v26
    v_lshlrev_b32 v2, 1, v2
    v_add_u32 v2, 0, v2
    v_cndmask_b32 v6, v15, v2, vcc
    s_branch L_ld_go
L_help2:
    s_setprio 3
    v_mov_b32 v8, 163712
    v_mov_b32 v3, 1
    s_getpc_b64 s[92:93]
L_tp_11:
    s_add_u32 s92, s92, L_tab-L_tp_11
    s_addc_u32 s93, s93, 0
    s_mov_b32 s72, s50
    s_and_b32 s73, s51, 0xffff
    s_mov_b32 s74, 0xa00000
    s_mov_b32 s75, 0x20000
    v_lshrrev_b32 v4, 5, v0
    v_xor_b32 v4, v4, v11
    v_lshlrev_b32 v4, 4, v4
    v_lshl_add_u32 v4, v11, 10, v4
    v_bfe_u32 v5, v0, 2, 1
    v_lshl_add_u32 v4, v5, 6, v4
    v_bfe_u32 v5, v0, 3, 2
    v_lshl_add_u32 v4, v5, 2, v4
    v_add_u32 v24, s58, v4
    v_xor_b32 v25, 32, v24
    v_and_b32 v4, 7, v0
    v_lshlrev_b32 v4, 4, v4
    v_lshl_add_u32 v28, v12, 13, v4
    s_lshl_b32 s10, s55, 18
    s_lshl_b32 s12, s60, 17
    s_add_u32 s10, s10, s12
    s_lshl_b32 s12, s59, 7
    s_add_u32 s10, s10, s12
    s_add_u32 s10, s10, 0x600000
    s_add_u32 s11, s10, 4096
    s_add_u32 s52, s10, 0x10000
    s_add_u32 s53, s10, 0x11000
    s_lshl_b32 s12, s55, 1
    s_add_u32 s12, s12, s60
    s_lshl_b32 s12, s12, 2
    s_lshr_b32 s13, s59, 3
    s_add_u32 s12, s12, s13
    s_lshl_b32 s12, s12, 7
    s_and_b32 s13, s59, 7
    s_lshl_b32 s13, s13, 2
    s_add_u32 s12, s12, s13
    s_add_u32 s54, s12, 0xd000
    s_mov_b32 s12, 0x05040100
    s_mov_b32 s13, 0x07060302
    s_load_dword s56, s[50:51], s54 glc
    s_lshl_b32 s94, s60, 2
    s_add_u32 s94, s94, 163736
    v_mov_b32 v9, s94
    s_cmp_lg_u32 s60, 0
    s_cbranch_scc1 L_h_np
    s_waitcnt vmcnt(6)
    s_mov_b64 exec, 1
    ds_write_b32 v8, v3 offset:48
    s_mov_b64 exec, -1
L_h_np:
    s_waitcnt lgkmcnt(0)
    s_add_u32 s62, s62, 0x9e3779b9
    s_mov_b32 s63, s62
    v_mov_b32 v2, s62
    s_mov_b64 exec, 1
    ds_write_b64 v8, v[2:3] offset:8
    s_mov_b64 exec, -1
    s_waitcnt vmcnt(0)
    ds_read2_b32 v[32:33], v24 offset0:0 offset1:32
    ds_read2_b32 v[34:35], v24 offset0:64 offset1:96
    ds_read2_b32 v[36:37], v24 offset0:128 offset1:160
    ds_read2_b32 v[38:39], v24 offset0:192 offset1:224
    ds_read2_b32 v[40:41], v25 offset0:0 offset1:32
    ds_read2_b32 v[42:43], v25 offset0:64 offset1:96
    ds_read2_b32 v[44:45], v25 offset0:128 offset1:160
    ds_read2_b32 v[46:47], v25 offset0:192 offset1:224
    s_waitcnt lgkmcnt(4)
    v_perm_b32 v48, v33, v32, s12
    v_perm_b32 v49, v35, v34, s12
    v_perm_b32 v50, v37, v36, s12
    v_perm_b32 v51, v39, v38, s12
    buffer_store_dwordx4 v[48:51], v28, s[72:75], s10 offen sc1
    v_perm_b32 v52, v33, v32, s13
    v_perm_b32 v53, v35, v34, s13
    v_perm_b32 v54, v37, v36, s13
    v_perm_b32 v55, v39, v38, s13
    buffer_store_dwordx4 v[52:55], v28, s[72:75], s11 offen sc1
    s_waitcnt lgkmcnt(0)
    v_perm_b32 v56, v41, v40, s12
    v_perm_b32 v57, v43, v42, s12
    v_perm_b32 v58, v45, v44, s12
    v_perm_b32 v59, v47, v46, s12
    buffer_store_dwordx4 v[56:59], v28, s[72:75], s52 offen sc1
    v_perm_b32 v60, v41, v40, s13
    v_perm_b32 v61, v43, v42, s13
    v_perm_b32 v62, v45, v44, s13
    v_perm_b32 v63, v47, v46, s13
    buffer_store_dwordx4 v[60:63], v28, s[72:75], s53 offen sc1
    s_mul_i32 s14, s2, 5504
    s_mul_i32 s15, s60, 2816
    s_add_u32 s14, s14, s15
    s_add_u32 s14, s40, s14
    s_addc_u32 s15, s41, 0
    v_lshlrev_b32 v4, 7, v0
    s_lshr_b32 exec_lo, 0x3fffff, s60
    s_mov_b32 exec_hi, 0
    global_load_dword v73, v4, s[14:15]
    s_mul_i32 s14, s59, 43
    s_mul_i32 s15, s60, 22
    s_add_u32 s14, s14, s15
    s_lshl_b32 s14, s14, 10
    s_add_u32 s14, s14, 384
    s_add_u32 s14, s40, s14
    s_addc_u32 s15, s41, 0
    v_lshlrev_b32 v4, 10, v0
    global_load_dword v75, v4, s[14:15]
    s_mov_b64 exec, 1
    ds_write_b32 v9, v3
    s_mov_b64 exec, -1
    s_setprio 0
    s_waitcnt vmcnt(2)
    s_mov_b32 s9, s62
    s_atomic_swap s9, s[50:51], s54
    s_cmp_eq_u32 s60, 0
    s_cbranch_scc1 L_h_done
    s_lshr_b32 s10, s2, 4
    s_lshl_b32 s10, s10, 9
    s_add_u32 s52, s10, 0xd000
    s_add_u32 s53, s52, 128
    s_add_u32 s54, s52, 256
    s_add_u32 s55, s52, 384
    s_lshl_b32 s10, s2, 13
    s_add_u32 s10, s10, 0x600000
    s_add_u32 s11, s10, 4096
    s_mov_b32 m0, 152064
    v_lshlrev_b32 v13, 4, v0
    v_mov_b32 v9, 8
    s_waitcnt lgkmcnt(0)
L_h_uw:
    s_sleep 6
    s_load_dwordx8 s[16:23], s[50:51], s52 glc
    s_load_dwordx8 s[24:31], s[50:51], s53 glc
    s_load_dwordx8 s[32:39], s[50:51], s54 glc
    s_load_dwordx8 s[40:47], s[50:51], s55 glc
    s_add_u32 s66, s66, 0x1000
    s_cbranch_scc1 L_end
    s_waitcnt lgkmcnt(0)
    s_xor_b64 s[16:17], s[16:17], s[62:63]
    s_xor_b64 s[18:19], s[18:19], s[62:63]
    s_xor_b64 s[20:21], s[20:21], s[62:63]
    s_xor_b64 s[22:23], s[22:23], s[62:63]
    s_xor_b64 s[24:25], s[24:25], s[62:63]
    s_xor_b64 s[26:27], s[26:27], s[62:63]
    s_xor_b64 s[28:29], s[28:29], s[62:63]
    s_xor_b64 s[30:31], s[30:31], s[62:63]
    s_xor_b64 s[32:33], s[32:33], s[62:63]
    s_xor_b64 s[34:35], s[34:35], s[62:63]
    s_xor_b64 s[36:37], s[36:37], s[62:63]
    s_xor_b64 s[38:39], s[38:39], s[62:63]
    s_xor_b64 s[40:41], s[40:41], s[62:63]
    s_xor_b64 s[42:43], s[42:43], s[62:63]
    s_xor_b64 s[44:45], s[44:45], s[62:63]
    s_xor_b64 s[46:47], s[46:47], s[62:63]
    s_or_b64 s[16:17], s[16:17], s[18:19]
    s_or_b64 s[16:17], s[16:17], s[20:21]
    s_or_b64 s[16:17], s[16:17], s[22:23]
    s_or_b64 s[16:17], s[16:17], s[24:25]
    s_or_b64 s[16:17], s[16:17], s[26:27]
    s_or_b64 s[16:17], s[16:17], s[28:29]
    s_or_b64 s[16:17], s[16:17], s[30:31]
    s_or_b64 s[16:17], s[16:17], s[32:33]
    s_or_b64 s[16:17], s[16:17], s[34:35]
    s_or_b64 s[16:17], s[16:17], s[36:37]
    s_or_b64 s[16:17], s[16:17], s[38:39]
    s_or_b64 s[16:17], s[16:17], s[40:41]
    s_or_b64 s[16:17], s[16:17], s[42:43]
    s_or_b64 s[16:17], s[16:17], s[44:45]
    s_or_b64 s[16:17], s[16:17], s[46:47]
    s_cbranch_scc1 L_h_uw
L_h_ud_12:
    ds_read_b32 v10, v8 offset:24
    s_add_u32 s66, s66, 0x1000
    s_cbranch_scc1 L_end
    s_waitcnt lgkmcnt(0)
    v_cmp_gt_u32 vcc, 1, v10
    s_cbranch_vccnz L_h_ud_12
    buffer_load_dwordx4 v13, s[72:75], s10 offen offset:0 sc1 lds
    buffer_load_dwordx4 v13, s[72:75], s10 offen offset:1024 sc1 lds
    buffer_load_dwordx4 v13, s[72:75], s10 offen offset:2048 sc1 lds
    buffer_load_dwordx4 v13, s[72:75], s10 offen offset:3072 sc1 lds
    s_mov_b32 m0, 156672
    s_nop 0
    buffer_load_dwordx4 v13, s[72:75], s11 offen offset:0 sc1 lds
    buffer_load_dwordx4 v13, s[72:75], s11 offen offset:1024 sc1 lds
    buffer_load_dwordx4 v13, s[72:75], s11 offen offset:2048 sc1 lds
    buffer_load_dwordx4 v13, s[72:75], s11 offen offset:3072 sc1 lds
    s_mov_b32 m0, s94
    s_mov_b64 exec, 1
    global_load_lds_dword v9, s[92:93]
    s_mov_b64 exec, -1
    s_cmpk_lg_u32 s2, 255
    s_cbranch_scc1 L_h_done
    v_lshlrev_b32 v4, 7, v0
    v_add_u32 v4, 0xd000, v4
L_h_bump:
    buffer_load_dwordx4 v[10:13], v4, s[72:75], 0 offen sc1
    buffer_load_dwordx4 v[14:17], v4, s[72:75], 0 offen offset:16 sc1
    s_waitcnt vmcnt(0)
    v_bitop3_b32 v10, v10, v11, v2 bitop3:0x7e
    v_bitop3_b32 v11, v12, v13, v2 bitop3:0x7e
    v_bitop3_b32 v12, v14, v15, v2 bitop3:0x7e
    v_bitop3_b32 v13, v16, v17, v2 bitop3:0x7e
    v_or3_b32 v10, v10, v11, v12
    v_or_b32 v10, v10, v13
    v_cmp_ne_u32 vcc, 0, v10
    s_cbranch_vccz L_h_ok
    s_add_u32 s66, s66, 0x1000
    s_cbranch_scc1 L_end
    s_sleep 16
    s_branch L_h_bump
L_h_ok:
    v_mov_b32 v4, 0
    s_mov_b64 exec, 1
    buffer_store_dword v2, v4, s[72:75], 0 offen sc1
L_h_done:
    s_waitcnt vmcnt(0) lgkmcnt(0)
    s_endpgm
L_h_w2:
    s_branch L_h_done
L_w2:
    v_lshrrev_b32 v1, 3, v0
    v_lshlrev_b32 v1, 10, v1
    v_lshrrev_b32 v2, 4, v0
    v_lshlrev_b32 v2, 1, v2
    v_and_b32 v3, 7, v0
    v_xor_b32 v2, v2, v3
    v_lshl_add_u32 v16, v2, 4, v1
    v_add_u32 v17, 7168, v16
    v_add_u32 v18, 14336, v16
    v_add_u32 v19, 21504, v16
    s_mov_b32 s4, s40
    s_and_b32 s5, s41, 0xffff
    s_mov_b32 s6, 0x158000
    s_mov_b32 s7, 0x20000
    s_lshr_b32 s55, s2, 5
    s_lshl_b32 s10, s55, 7
    s_lshl_b32 s14, s98, 14
    s_add_u32 s14, s14, s10
    s_add_u32 s14, s14, 1376256
    s_mul_i32 s11, s98, 688128
    s_add_u32 s52, s10, s11
    s_add_u32 s53, s52, 688128
    s_mul_i32 s11, s98, 12288
    s_mov_b32 s13, 0
    s_add_u32 s10, s13, 5
    s_cmp_ge_u32 s10, 7
    s_cselect_b32 s12, 7, 0
    s_sub_u32 s10, s10, s12
    s_mul_i32 s10, s10, 98304
    s_add_u32 s10, s10, s52
L_w2_rg_14:
    ds_read_b32 v21, v8 offset:20
    s_add_u32 s66, s66, 0x1000
    s_cbranch_scc1 L_end
    s_waitcnt lgkmcnt(0)
    v_cmp_gt_u32 vcc, 7, v21
    s_cbranch_vccnz L_w2_rg_14
    buffer_load_dwordx4 v[32:35], v16, s[4:7], s10 offen offset:0
    buffer_load_dwordx4 v[36:39], v17, s[4:7], s10 offen offset:1024
    buffer_load_dwordx4 v[40:43], v18, s[4:7], s10 offen offset:2048
    buffer_load_dwordx4 v[44:47], v19, s[4:7], s10 offen offset:3072
    s_add_u32 s10, s10, 32768
    buffer_load_dwordx4 v[48:51], v16, s[4:7], s10 offen offset:0
    buffer_load_dwordx4 v[52:55], v17, s[4:7], s10 offen offset:1024
    buffer_load_dwordx4 v[56:59], v18, s[4:7], s10 offen offset:2048
    buffer_load_dwordx4 v[60:63], v19, s[4:7], s10 offen offset:3072
    s_add_u32 s10, s10, 32768
    buffer_load_dwordx4 v[64:67], v16, s[4:7], s10 offen offset:0
    buffer_load_dwordx4 v[68:71], v17, s[4:7], s10 offen offset:1024
    buffer_load_dwordx4 v[72:75], v18, s[4:7], s10 offen offset:2048
    buffer_load_dwordx4 v[76:79], v19, s[4:7], s10 offen offset:3072
    s_add_u32 s10, s10, 32768
    s_cmp_eq_u32 s10, s53
    s_cselect_b32 s10, s52, s10
    buffer_load_dwordx4 v[80:83], v16, s[4:7], s10 offen offset:0
    buffer_load_dwordx4 v[84:87], v17, s[4:7], s10 offen offset:1024
    buffer_load_dwordx4 v[88:91], v18, s[4:7], s10 offen offset:2048
    buffer_load_dwordx4 v[92:95], v19, s[4:7], s10 offen offset:3072
    s_add_u32 s10, s10, 32768
    buffer_load_dwordx4 v[96:99], v16, s[4:7], s10 offen offset:0
    buffer_load_dwordx4 v[100:103], v17, s[4:7], s10 offen offset:1024
    buffer_load_dwordx4 v[104:107], v18, s[4:7], s10 offen offset:2048
    buffer_load_dwordx4 v[108:111], v19, s[4:7], s10 offen offset:3072
    s_add_u32 s10, s10, 32768
    buffer_load_dwordx4 v[112:115], v16, s[4:7], s10 offen offset:0
    buffer_load_dwordx4 v[116:119], v17, s[4:7], s10 offen offset:1024
    buffer_load_dwordx4 v[120:123], v18, s[4:7], s10 offen offset:2048
    buffer_load_dwordx4 v[124:127], v19, s[4:7], s10 offen offset:3072
    s_add_u32 s10, s10, 32768
    s_cmp_eq_u32 s10, s53
    s_cselect_b32 s10, s52, s10
    s_mov_b32 s96, 0x130d0701
    s_mov_b32 s97, 0x19
    s_mov_b32 s99, 0x87765
    ds_read_b32 v20, v13
    s_waitcnt lgkmcnt(0)
    v_cmp_gt_u32 vcc, 6, v20
    s_cbranch_vccz L_w2_m_17
L_w2_m_16:
    ds_read_b32 v20, v13
    s_add_u32 s66, s66, 0x1000
    s_cbranch_scc1 L_end
    s_waitcnt lgkmcnt(0)
    v_cmp_gt_u32 vcc, 6, v20
    s_cbranch_vccnz L_w2_m_16
L_w2_m_17:
    s_lshl_b32 m0, s98, 11
    s_nop 0
    buffer_load_dwordx4 v16, s[4:7], s14 offen offset:0 lds
    buffer_load_dwordx4 v17, s[4:7], s14 offen offset:1024 lds
L_w2_loop:
    s_and_b32 s13, s96, 0xff
    s_lshl_b32 s13, s13, 12
    s_add_u32 s13, s13, s11
    s_add_u32 m0, s13, 0
    s_nop 0
    buffer_load_dwordx4 v16, s[4:7], s10 offen offset:0 lds
    buffer_load_dwordx4 v17, s[4:7], s10 offen offset:1024 lds
    buffer_load_dwordx4 v18, s[4:7], s10 offen offset:2048 lds
    buffer_load_dwordx4 v19, s[4:7], s10 offen offset:3072 lds
    s_add_u32 s10, s10, 32768
    s_add_u32 m0, s13, 4096
    s_nop 0
    buffer_load_dwordx4 v16, s[4:7], s10 offen offset:0 lds
    buffer_load_dwordx4 v17, s[4:7], s10 offen offset:1024 lds
    buffer_load_dwordx4 v18, s[4:7], s10 offen offset:2048 lds
    buffer_load_dwordx4 v19, s[4:7], s10 offen offset:3072 lds
    s_add_u32 s10, s10, 32768
    s_add_u32 m0, s13, 8192
    ds_read_b32 v20, v13
    buffer_load_dwordx4 v16, s[4:7], s10 offen offset:0 lds
    buffer_load_dwordx4 v17, s[4:7], s10 offen offset:1024 lds
    buffer_load_dwordx4 v18, s[4:7], s10 offen offset:2048 lds
    buffer_load_dwordx4 v19, s[4:7], s10 offen offset:3072 lds
    s_add_u32 s10, s10, 32768
    s_cmp_eq_u32 s10, s53
    s_cselect_b32 s10, s52, s10
    v_add_u32 v9, 4, v9
    s_mov_b32 m0, s94
    s_mov_b64 exec, 1
    global_load_lds_dword v9, s[92:93]
    s_mov_b64 exec, -1
    s_lshr_b64 s[96:97], s[96:97], 8
    s_lshr_b32 s99, s99, 4
    s_cbranch_scc0 L_w2_done
    s_and_b32 s15, s99, 15
    s_waitcnt lgkmcnt(0)
    v_cmp_gt_u32 vcc, s15, v20
    s_cbranch_vccz L_w2_f_19
L_w2_f_18:
    ds_read_b32 v20, v13
    s_add_u32 s66, s66, 0x1000
    s_cbranch_scc1 L_end
    s_waitcnt lgkmcnt(0)
    v_cmp_gt_u32 vcc, s15, v20
    s_cbranch_vccnz L_w2_f_18
L_w2_f_19:
    s_cmp_lg_u32 s99, 0x877
    s_cbranch_scc1 L_w2_loop
L_w2_s_20:
    ds_read_b32 v21, v8 offset:0
    s_add_u32 s66, s66, 0x1000
    s_cbranch_scc1 L_end
    s_waitcnt lgkmcnt(0)
    v_cmp_gt_u32 vcc, 4, v21
    s_cbranch_vccnz L_w2_s_20
    s_branch L_w2_loop
L_w2_done:
    v_lshl_add_u32 v4, v0, 4, s11
    v_mov_b32 v5, s94
    s_waitcnt vmcnt(0)
    s_branch L_w2_r_23
L_w2_r_22:
    s_sleep 4
L_w2_r_23:
    ds_read_b32 v20, v13 offset:0
    s_add_u32 s66, s66, 0x1000
    s_cbranch_scc1 L_end
    s_waitcnt lgkmcnt(0)
    v_cmp_gt_u32 vcc, 9, v20
    s_cbranch_vccnz L_w2_r_22
    ds_write_b128 v4, v[32:35] offset:4096
    ds_write_b128 v4, v[36:39] offset:5120
    ds_write_b128 v4, v[40:43] offset:6144
    ds_write_b128 v4, v[44:47] offset:7168
    ds_write_b128 v4, v[48:51] offset:8192
    ds_write_b128 v4, v[52:55] offset:9216
    ds_write_b128 v4, v[56:59] offset:10240
    ds_write_b128 v4, v[60:63] offset:11264
    ds_write_b128 v4, v[64:67] offset:12288
    ds_write_b128 v4, v[68:71] offset:13312
    ds_write_b128 v4, v[72:75] offset:14336
    ds_write_b128 v4, v[76:79] offset:15360
    v_mov_b32 v6, 14
    s_mov_b64 exec, 1
    ds_write_b32 v5, v6
    s_mov_b64 exec, -1
    s_branch L_w2_r_25
L_w2_r_24:
    s_sleep 4
L_w2_r_25:
    ds_read_b32 v20, v13 offset:0
    s_add_u32 s66, s66, 0x1000
    s_cbranch_scc1 L_end
    s_waitcnt lgkmcnt(0)
    v_cmp_gt_u32 vcc, 10, v20
    s_cbranch_vccnz L_w2_r_24
    ds_write_b128 v4, v[80:83] offset:28672
    ds_write_b128 v4, v[84:87] offset:29696
    ds_write_b128 v4, v[88:91] offset:30720
    ds_write_b128 v4, v[92:95] offset:31744
    ds_write_b128 v4, v[96:99] offset:32768
    ds_write_b128 v4, v[100:103] offset:33792
    ds_write_b128 v4, v[104:107] offset:34816
    ds_write_b128 v4, v[108:111] offset:35840
    ds_write_b128 v4, v[112:115] offset:36864
    ds_write_b128 v4, v[116:119] offset:37888
    ds_write_b128 v4, v[120:123] offset:38912
    ds_write_b128 v4, v[124:127] offset:39936
    v_mov_b32 v6, 15
    s_mov_b64 exec, 1
    ds_write_b32 v5, v6
    s_mov_b64 exec, -1
    s_waitcnt lgkmcnt(0)
    s_endpgm
.p2align 8
L_ssm:
    v_and_b32 v0, 63, v0
    s_mov_b32 s66, 0
    s_sub_u32 s60, s3, 8
    s_and_b32 s52, s60, 1
    s_lshr_b32 s53, s60, 1
    s_lshl_b32 s13, s2, 2
    s_waitcnt lgkmcnt(0)
    s_load_dword s14, s[30:31], s13
    s_load_dword s15, s[32:33], s13
    s_barrier
    s_setprio 1
    s_and_b32 s59, s2, 7
    s_lshl_b32 s59, s59, 2
    s_bfe_u32 s54, s2, 0x20003
    s_add_u32 s59, s59, s54
    s_lshr_b32 s55, s2, 5
    v_mov_b32 v9, 163712
    v_mov_b32 v8, 1
    s_mov_b32 s72, s50
    s_and_b32 s73, s51, 0xffff
    s_mov_b32 s74, 0xa00000
    s_mov_b32 s75, 0x20000
    v_and_b32 v123, 15, v0
    v_lshrrev_b32 v124, 4, v0
    v_lshlrev_b32 v13, 4, v0
    s_lshl_b32 s10, s55, 7
    s_lshl_b32 s9, s60, 5
    s_add_u32 s10, s10, s9
    v_lshl_add_u32 v3, v124, 3, s10
    global_load_dwordx2 v[98:99], v3, s[42:43]
    s_mul_i32 s12, s52, 4608
    s_add_u32 s12, s12, 151584
    v_lshl_add_u32 v12, v0, 3, s12
    v_mov_b64 v[2:3], 0
    s_mov_b32 exec_hi, 0x0fffffff
    ds_write_b64 v12, v[2:3]
    s_mov_b64 exec, -1
    v_and_b32 v1, 31, v0
    v_lshrrev_b32 v2, 5, v0
    v_lshlrev_b32 v2, 4, v2
    v_sub_u32 v1, v1, v2
    v_and_b32 v2, 1, v1
    v_lshlrev_b32 v2, 4, v2
    v_mov_b32 v3, 0x3f80
    v_lshlrev_b32 v2, v2, v3
    v_ashrrev_i32 v1, 1, v1
    v_cmp_eq_u32 vcc, 0, v1
    s_nop 1
    v_cndmask_b32 v158, 0, v2, vcc
    v_cmp_eq_u32 vcc, 1, v1
    s_nop 1
    v_cndmask_b32 v159, 0, v2, vcc
    v_cmp_eq_u32 vcc, 2, v1
    s_nop 1
    v_cndmask_b32 v160, 0, v2, vcc
    v_cmp_eq_u32 vcc, 3, v1
    s_nop 1
    v_cndmask_b32 v161, 0, v2, vcc
    v_cmp_eq_u32 vcc, 4, v1
    s_nop 1
    v_cndmask_b32 v162, 0, v2, vcc
    v_cmp_eq_u32 vcc, 5, v1
    s_nop 1
    v_cndmask_b32 v163, 0, v2, vcc
    v_cmp_eq_u32 vcc, 6, v1
    s_nop 1
    v_cndmask_b32 v164, 0, v2, vcc
    v_cmp_eq_u32 vcc, 7, v1
    s_nop 1
    v_cndmask_b32 v165, 0, v2, vcc
    s_lshl_b32 s12, s52, 8
    s_lshl_b32 s13, s53, 7
    s_add_u32 s12, s12, s13
    s_add_u32 s12, s12, 131072
    v_lshl_add_u32 v6, v0, 1, s12
    s_mul_i32 s11, s52, 5632
    s_mul_i32 s12, s53, 2816
    s_add_u32 s57, s11, s12
    s_add_u32 s57, s57, 53248
    s_add_u32 s56, s11, 53248
    v_lshlrev_b32 v3, 2, v124
    v_lshl_add_u32 v120, v123, 4, v3
    v_lshl_add_u32 v3, v123, 3, v3
    v_lshlrev_b32 v2, 6, v124
    v_lshl_add_u32 v4, v123, 2, v2
    v_cmp_gt_u32 vcc, 2, v124
    v_lshl_add_u32 v122, v123, 1, v2
    v_add_u32 v122, 512, v122
    v_cndmask_b32 v121, v4, v3, vcc
    v_add_u32 v121, 256, v121
    v_mov_b32 v125, s57
    v_lshrrev_b32 v2, 5, v120
    v_add_u32 v120, v120, v2
    v_lshl_add_u32 v120, v120, 2, s57
    v_lshrrev_b32 v2, 5, v121
    v_add_u32 v121, v121, v2
    v_lshl_add_u32 v121, v121, 2, s57
    v_lshrrev_b32 v2, 5, v122
    v_add_u32 v122, v122, v2
    v_lshl_add_u32 v122, v122, 2, s57
    s_mul_i32 s11, s52, 9280
    s_add_u32 s11, s11, 131072
    s_lshl_b32 s12, s53, 10
    s_add_u32 s12, s12, s11
    s_add_u32 s12, s12, 64
    v_lshl_add_u32 v12, v0, 4, s12
    v_mul_u32_u24 v3, 2240, v124
    v_lshl_add_u32 v3, v123, 2, v3
    s_mul_i32 s12, s53, 2112
    s_add_u32 s12, s12, s11
    v_add_u32 v3, s12, v3
    v_lshl_add_u32 v11, v0, 2, s11
    v_mov_b32 v2, 0
    ds_write_b32 v3, v2
    s_mov_b64 exec, 0xffff
    ds_write_b32 v11, v2 offset:9216
    s_mov_b64 exec, -1
    v_mul_u32_u24 v119, 2240, v0
    v_add_u32 v119, s11, v119
    s_mul_i32 s13, s52, 4608
    s_add_u32 s13, s13, 151584
    v_lshlrev_b32 v3, 4, v124
    v_lshl_add_u32 v3, v123, 5, v3
    v_add_u32 v14, s13, v3
    v_sub_u32 v3, 15, v123
    v_and_b32 v15, 3, v3
    v_mul_u32_u24 v15, 2240, v15
    v_lshrrev_b32 v3, 2, v3
    v_lshl_add_u32 v3, v124, 1, v3
    v_lshl_add_u32 v15, v3, 3, v15
    v_add_u32 v15, s11, v15
    v_lshlrev_b32 v3, 2, v124
    v_sub_u32 v3, v3, v123
    v_add_u32 v3, 2255, v3
    v_lshl_add_u32 v118, v3, 2, s11
    v_and_b32 v3, 7, v0
    v_lshl_add_u32 v62, v3, 2, v9
    v_lshlrev_b32 v3, 2, v3
    v_mov_b32 v63, 0x66660088
    v_lshrrev_b32 v63, v3, v63
    v_and_b32 v63, 15, v63
    v_and_b32 v3, 1, v0
    v_mul_u32_u24 v96, 28, v3
    v_add_u32 v96, v96, v9
    v_lshlrev_b32 v3, 1, v3
    v_sub_u32 v97, 4, v3
    s_lshl_b32 s12, s53, 9
    s_sub_u32 s12, 1023, s12
    v_lshlrev_b32 v1, 3, v0
    v_sub_u32 v1, s12, v1
    v_cvt_f32_i32 v4, v1
    v_subrev_u32 v2, 0, v1
    v_subrev_f32 v3, 0x0, v4
    v_cvt_pk_bf16_f32 v3, v3, 0
    v_min_i32 v2, 128, v2
    v_subrev_u32 v3, 0x4280, v3
    v_max_i32 v3, v3, v2
    v_lshrrev_b32 v2, 5, v3
    v_add_u32 v3, v3, v2
    v_lshl_add_u32 v100, v3, 2, s56
    v_subrev_u32 v2, 1, v1
    v_subrev_f32 v3, 0x3f800000, v4
    v_cvt_pk_bf16_f32 v3, v3, 0
    v_min_i32 v2, 128, v2
    v_subrev_u32 v3, 0x4280, v3
    v_max_i32 v3, v3, v2
    v_lshrrev_b32 v2, 5, v3
    v_add_u32 v3, v3, v2
    v_lshl_add_u32 v101, v3, 2, s56
    v_subrev_u32 v2, 2, v1
    v_subrev_f32 v3, 0x40000000, v4
    v_cvt_pk_bf16_f32 v3, v3, 0
    v_min_i32 v2, 128, v2
    v_subrev_u32 v3, 0x4280, v3
    v_max_i32 v3, v3, v2
    v_lshrrev_b32 v2, 5, v3
    v_add_u32 v3, v3, v2
    v_lshl_add_u32 v102, v3, 2, s56
    v_subrev_u32 v2, 3, v1
    v_subrev_f32 v3, 0x40400000, v4
    v_cvt_pk_bf16_f32 v3, v3, 0
    v_min_i32 v2, 128, v2
    v_subrev_u32 v3, 0x4280, v3
    v_max_i32 v3, v3, v2
    v_lshrrev_b32 v2, 5, v3
    v_add_u32 v3, v3, v2
    v_lshl_add_u32 v103, v3, 2, s56
    v_subrev_u32 v2, 4, v1
    v_subrev_f32 v3, 0x40800000, v4
    v_cvt_pk_bf16_f32 v3, v3, 0
    v_min_i32 v2, 128, v2
    v_subrev_u32 v3, 0x4280, v3
    v_max_i32 v3, v3, v2
    v_lshrrev_b32 v2, 5, v3
    v_add_u32 v3, v3, v2
    v_lshl_add_u32 v104, v3, 2, s56
    v_subrev_u32 v2, 5, v1
    v_subrev_f32 v3, 0x40a00000, v4
    v_cvt_pk_bf16_f32 v3, v3, 0
    v_min_i32 v2, 128, v2
    v_subrev_u32 v3, 0x4280, v3
    v_max_i32 v3, v3, v2
    v_lshrrev_b32 v2, 5, v3
    v_add_u32 v3, v3, v2
    v_lshl_add_u32 v105, v3, 2, s56
    v_subrev_u32 v2, 6, v1
    v_subrev_f32 v3, 0x40c00000, v4
    v_cvt_pk_bf16_f32 v3, v3, 0
    v_min_i32 v2, 128, v2
    v_subrev_u32 v3, 0x4280, v3
    v_max_i32 v3, v3, v2
    v_lshrrev_b32 v2, 5, v3
    v_add_u32 v3, v3, v2
    v_lshl_add_u32 v106, v3, 2, s56
    v_subrev_u32 v2, 7, v1
    v_subrev_f32 v3, 0x40e00000, v4
    v_cvt_pk_bf16_f32 v3, v3, 0
    v_min_i32 v2, 128, v2
    v_subrev_u32 v3, 0x4280, v3
    v_max_i32 v3, v3, v2
    v_lshrrev_b32 v2, 5, v3
    v_add_u32 v3, v3, v2
    v_lshl_add_u32 v107, v3, 2, s56
    v_subrev_u32 v2, 8, v1
    v_subrev_f32 v3, 0x41000000, v4
    v_cvt_pk_bf16_f32 v3, v3, 0
    v_min_i32 v2, 128, v2
    v_subrev_u32 v3, 0x4280, v3
    v_max_i32 v3, v3, v2
    v_min_u32 v3, 660, v3
    v_lshrrev_b32 v2, 5, v3
    v_add_u32 v3, v3, v2
    v_lshl_add_u32 v108, v3, 2, s56
    v_subrev_u32 v2, 9, v1
    v_subrev_f32 v3, 0x41100000, v4
    v_cvt_pk_bf16_f32 v3, v3, 0
    v_min_i32 v2, 128, v2
    v_subrev_u32 v3, 0x4280, v3
    v_max_i32 v3, v3, v2
    v_min_u32 v3, 660, v3
    v_lshrrev_b32 v2, 5, v3
    v_add_u32 v3, v3, v2
    v_lshl_add_u32 v109, v3, 2, s56
    v_subrev_u32 v2, 10, v1
    v_subrev_f32 v3, 0x41200000, v4
    v_cvt_pk_bf16_f32 v3, v3, 0
    v_min_i32 v2, 128, v2
    v_subrev_u32 v3, 0x4280, v3
    v_max_i32 v3, v3, v2
    v_min_u32 v3, 660, v3
    v_lshrrev_b32 v2, 5, v3
    v_add_u32 v3, v3, v2
    v_lshl_add_u32 v110, v3, 2, s56
    v_lshlrev_b32 v1, 1, v0
    v_sub_u32 v111, 639, v1
    v_sub_u32 v112, 640, v1
    v_lshrrev_b32 v3, 5, v111
    v_add_u32 v111, v111, v3
    v_lshl_add_u32 v111, v111, 2, s56
    v_lshrrev_b32 v3, 5, v112
    v_add_u32 v112, v112, v3
    v_lshl_add_u32 v112, v112, 2, s56
    s_mul_i32 s10, s2, 5504
    s_mul_i32 s11, s60, 1408
    s_min_u32 s11, s11, 4096
    s_add_u32 s10, s10, s11
    s_add_u32 s34, s40, s10
    s_addc_u32 s35, s41, 0
    s_lshl_b32 s10, s55, 3
    s_lshr_b32 s11, s59, 1
    s_xor_b32 s11, s11, s59
    s_and_b32 s11, s11, 4
    s_add_u32 s10, s10, s11
    s_add_u32 s10, s10, s60
    s_lshl_b32 s10, s10, 7
    s_add_u32 s100, s10, 0xf000
    s_lshl_b32 s10, s59, 7
    s_add_u32 s101, s10, 0xc000
    s_branch L_s_par_27
L_s_par_26:
    s_sleep 2
L_s_par_27:
    ds_read_b32 v10, v9 offset:48
    s_add_u32 s66, s66, 0x1000
    s_cbranch_scc1 L_end
    s_waitcnt lgkmcnt(0)
    v_cmp_gt_u32 vcc, 1, v10
    s_cbranch_vccnz L_s_par_26
    ds_read_u16 v16, v6 offset:64
    ds_read_u16 v17, v6 offset:576
    ds_read_u16 v18, v6 offset:1088
    ds_read_u16 v19, v6 offset:1600
    ds_read_u16 v20, v6 offset:2304
    ds_read_u16 v21, v6 offset:2816
    s_lshl_b32 s11, s52, 4
    s_lshr_b32 s14, s14, s11
    s_lshl_b32 s14, s14, 16
    s_lshr_b32 s15, s15, s11
    s_lshl_b32 s15, s15, 16
    v_mov_b32 v1, 0x3fb8aa3b
    v_mul_f32 v2, s14, v1
    v_exp_f32 v2, v2
    s_waitcnt lgkmcnt(0)
    v_lshlrev_b32 v16, 16, v16
    v_lshlrev_b32 v17, 16, v17
    v_lshlrev_b32 v18, 16, v18
    v_lshlrev_b32 v19, 16, v19
    v_lshlrev_b32 v20, 16, v20
    v_lshlrev_b32 v21, 16, v21
    v_cvt_pk_bf16_f32 v2, v2, v2
    v_lshlrev_b32 v2, 16, v2
    v_mul_f32 v16, v2, v16
    v_mul_f32 v17, v2, v17
    v_mul_f32 v18, v2, v18
    v_mul_f32 v19, v2, v19
    v_mul_f32 v16, v1, v16
    v_mul_f32 v17, 0x3e22f983, v17
    v_mul_f32 v20, 0x1f800000, v20
    v_mul_f32 v21, 0x1f800000, v21
    v_mul_f32 v3, 0x41800000, v16
    v_mul_f32 v7, 0x41800000, v17
    v_exp_f32 v3, v3
    v_fract_f32 v7, v7
    v_cos_f32 v24, v7
    v_sin_f32 v25, v7
    v_mul_f32 v24, v3, v24
    v_mul_f32 v25, v3, v25
    v_mul_f32 v28, v20, v18
    v_mul_f32 v29, v21, v18
    v_fma_f32 v28, -v21, v19, v28
    v_fmac_f32 v29, v20, v19
    v_mul_f32 v30, v28, v24
    v_mul_f32 v31, v29, v24
    v_fma_f32 v30, -v29, v25, v30
    v_fmac_f32 v31, v28, v25
    v_cvt_pk_bf16_f32 v64, v28, v30
    v_cvt_pk_bf16_f32 v72, -v29, -v31
    v_mul_f32 v28, v30, v24
    v_mul_f32 v29, v31, v24
    v_fma_f32 v28, -v31, v25, v28
    v_fmac_f32 v29, v30, v25
    v_mul_f32 v30, v28, v24
    v_mul_f32 v31, v29, v24
    v_fma_f32 v30, -v29, v25, v30
    v_fmac_f32 v31, v28, v25
    v_cvt_pk_bf16_f32 v65, v28, v30
    v_cvt_pk_bf16_f32 v73, -v29, -v31
    v_mul_f32 v28, v30, v24
    v_mul_f32 v29, v31, v24
    v_fma_f32 v28, -v31, v25, v28
    v_fmac_f32 v29, v30, v25
    v_mul_f32 v30, v28, v24
    v_mul_f32 v31, v29, v24
    v_fma_f32 v30, -v29, v25, v30
    v_fmac_f32 v31, v28, v25
    v_cvt_pk_bf16_f32 v66, v28, v30
    v_cvt_pk_bf16_f32 v74, -v29, -v31
    v_mul_f32 v28, v30, v24
    v_mul_f32 v29, v31, v24
    v_fma_f32 v28, -v31, v25, v28
    v_fmac_f32 v29, v30, v25
    v_mul_f32 v30, v28, v24
    v_mul_f32 v31, v29, v24
    v_fma_f32 v30, -v29, v25, v30
    v_fmac_f32 v31, v28, v25
    v_cvt_pk_bf16_f32 v67, v28, v30
    v_cvt_pk_bf16_f32 v75, -v29, -v31
    v_mul_f32 v28, v30, v24
    v_mul_f32 v29, v31, v24
    v_fma_f32 v28, -v31, v25, v28
    v_fmac_f32 v29, v30, v25
    v_mfma_f32_32x32x16_bf16 v[80:95], v[64:67], v[158:161], 0
    v_mfma_f32_32x32x16_bf16 v[142:157], v[72:75], v[158:161], 0
    v_mul_f32 v30, v28, v24
    v_mul_f32 v31, v29, v24
    v_fma_f32 v30, -v29, v25, v30
    v_fmac_f32 v31, v28, v25
    v_cvt_pk_bf16_f32 v68, v28, v30
    v_cvt_pk_bf16_f32 v76, -v29, -v31
    v_mul_f32 v28, v30, v24
    v_mul_f32 v29, v31, v24
    v_fma_f32 v28, -v31, v25, v28
    v_fmac_f32 v29, v30, v25
    v_mul_f32 v30, v28, v24
    v_mul_f32 v31, v29, v24
    v_fma_f32 v30, -v29, v25, v30
    v_fmac_f32 v31, v28, v25
    v_cvt_pk_bf16_f32 v69, v28, v30
    v_cvt_pk_bf16_f32 v77, -v29, -v31
    v_mul_f32 v28, v30, v24
    v_mul_f32 v29, v31, v24
    v_fma_f32 v28, -v31, v25, v28
    v_fmac_f32 v29, v30, v25
    v_mul_f32 v30, v28, v24
    v_mul_f32 v31, v29, v24
    v_fma_f32 v30, -v29, v25, v30
    v_fmac_f32 v31, v28, v25
    v_cvt_pk_bf16_f32 v70, v28, v30
    v_cvt_pk_bf16_f32 v78, -v29, -v31
    v_mul_f32 v28, v30, v24
    v_mul_f32 v29, v31, v24
    v_fma_f32 v28, -v31, v25, v28
    v_fmac_f32 v29, v30, v25
    v_mul_f32 v30, v28, v24
    v_mul_f32 v31, v29, v24
    v_fma_f32 v30, -v29, v25, v30
    v_fmac_f32 v31, v28, v25
    v_cvt_pk_bf16_f32 v71, v28, v30
    v_cvt_pk_bf16_f32 v79, -v29, -v31
    v_exp_f32 v3, v16
    v_fract_f32 v7, v17
    v_cos_f32 v22, v7
    v_sin_f32 v23, v7
    v_mul_f32 v22, v3, v22
    v_mul_f32 v23, v3, v23
    v_mfma_f32_32x32x16_bf16 v[80:95], v[68:71], v[162:165], v[80:95]
    v_mfma_f32_32x32x16_bf16 v[142:157], v[76:79], v[162:165], v[142:157]
    s_load_dword s17, s[50:51], s101 glc
    v_mov_b32 v4, 1.0
    v_mov_b32 v5, 0
    v_cvt_pk_bf16_f32 v64, v4, v22
    v_cvt_pk_bf16_f32 v72, v5, v23
    v_mul_f32 v32, v22, v22
    v_mul_f32 v33, v23, v22
    v_fma_f32 v32, -v23, v23, v32
    v_fmac_f32 v33, v22, v23
    v_mul_f32 v28, v32, v22
    v_mul_f32 v29, v33, v22
    v_fma_f32 v28, -v33, v23, v28
    v_fmac_f32 v29, v32, v23
    v_cvt_pk_bf16_f32 v65, v32, v28
    v_cvt_pk_bf16_f32 v73, v33, v29
    v_mul_f32 v34, v28, v22
    v_mul_f32 v35, v29, v22
    v_fma_f32 v34, -v29, v23, v34
    v_fmac_f32 v35, v28, v23
    v_mul_f32 v28, v34, v22
    v_mul_f32 v29, v35, v22
    v_fma_f32 v28, -v35, v23, v28
    v_fmac_f32 v29, v34, v23
    v_cvt_pk_bf16_f32 v66, v34, v28
    v_cvt_pk_bf16_f32 v74, v35, v29
    v_mul_f32 v36, v28, v22
    v_mul_f32 v37, v29, v22
    v_fma_f32 v36, -v29, v23, v36
    v_fmac_f32 v37, v28, v23
    v_mul_f32 v28, v36, v22
    v_mul_f32 v29, v37, v22
    v_fma_f32 v28, -v37, v23, v28
    v_fmac_f32 v29, v36, v23
    v_cvt_pk_bf16_f32 v67, v36, v28
    v_cvt_pk_bf16_f32 v75, v37, v29
    v_cvt_pk_bf16_f32 v80, v80, v81
    v_cvt_pk_bf16_f32 v81, v82, v83
    v_cvt_pk_bf16_f32 v84, v84, v85
    v_cvt_pk_bf16_f32 v85, v86, v87
    v_cvt_pk_bf16_f32 v88, v88, v89
    v_cvt_pk_bf16_f32 v89, v90, v91
    v_cvt_pk_bf16_f32 v92, v92, v93
    v_cvt_pk_bf16_f32 v93, v94, v95
    v_cvt_pk_bf16_f32 v82, v142, v143
    v_cvt_pk_bf16_f32 v83, v144, v145
    v_cvt_pk_bf16_f32 v86, v146, v147
    v_cvt_pk_bf16_f32 v87, v148, v149
    v_cvt_pk_bf16_f32 v90, v150, v151
    v_cvt_pk_bf16_f32 v91, v152, v153
    v_cvt_pk_bf16_f32 v94, v154, v155
    v_cvt_pk_bf16_f32 v95, v156, v157
    v_mul_f32 v38, v28, v22
    v_mul_f32 v39, v29, v22
    v_fma_f32 v38, -v29, v23, v38
    v_fmac_f32 v39, v28, v23
    v_mfma_f32_32x32x16_bf16 v[126:141], v[64:67], v[158:161], 0
    v_mfma_f32_32x32x16_bf16 v[142:157], v[72:75], v[158:161], 0
    v_mul_f32 v28, v38, v22
    v_mul_f32 v29, v39, v22
    v_fma_f32 v28, -v39, v23, v28
    v_fmac_f32 v29, v38, v23
    v_cvt_pk_bf16_f32 v68, v38, v28
    v_cvt_pk_bf16_f32 v76, v39, v29
    v_mul_f32 v40, v28, v22
    v_mul_f32 v41, v29, v22
    v_fma_f32 v40, -v29, v23, v40
    v_fmac_f32 v41, v28, v23
    v_mul_f32 v28, v40, v22
    v_mul_f32 v29, v41, v22
    v_fma_f32 v28, -v41, v23, v28
    v_fmac_f32 v29, v40, v23
    v_cvt_pk_bf16_f32 v69, v40, v28
    v_cvt_pk_bf16_f32 v77, v41, v29
    v_mul_f32 v42, v28, v22
    v_mul_f32 v43, v29, v22
    v_fma_f32 v42, -v29, v23, v42
    v_fmac_f32 v43, v28, v23
    v_mul_f32 v28, v42, v22
    v_mul_f32 v29, v43, v22
    v_fma_f32 v28, -v43, v23, v28
    v_fmac_f32 v29, v42, v23
    v_cvt_pk_bf16_f32 v70, v42, v28
    v_cvt_pk_bf16_f32 v78, v43, v29
    v_mul_f32 v44, v28, v22
    v_mul_f32 v45, v29, v22
    v_fma_f32 v44, -v29, v23, v44
    v_fmac_f32 v45, v28, v23
    v_mul_f32 v28, v44, v22
    v_mul_f32 v29, v45, v22
    v_fma_f32 v28, -v45, v23, v28
    v_fmac_f32 v29, v44, v23
    v_cvt_pk_bf16_f32 v71, v44, v28
    v_cvt_pk_bf16_f32 v79, v45, v29
    v_mul_f32 v3, 0x43800000, v16
    v_mul_f32 v7, 0x43800000, v17
    v_exp_f32 v3, v3
    v_fract_f32 v7, v7
    v_cos_f32 v26, v7
    v_sin_f32 v27, v7
    v_mul_f32 v26, v3, v26
    v_mul_f32 v27, v3, v27
    v_mfma_f32_32x32x16_bf16 v[126:141], v[68:71], v[162:165], v[126:141]
    v_mfma_f32_32x32x16_bf16 v[142:157], v[76:79], v[162:165], v[142:157]
    v_mul_f32 v28, v26, v32
    v_mul_f32 v29, v27, v32
    v_fma_f32 v28, -v27, v33, v28
    v_fmac_f32 v29, v26, v33
    v_cvt_pk_bf16_f32 v64, v26, v28
    v_cvt_pk_bf16_f32 v72, v27, v29
    v_mul_f32 v30, v26, v34
    v_mul_f32 v31, v27, v34
    v_fma_f32 v30, -v27, v35, v30
    v_fmac_f32 v31, v26, v35
    v_mul_f32 v28, v26, v36
    v_mul_f32 v29, v27, v36
    v_fma_f32 v28, -v27, v37, v28
    v_fmac_f32 v29, v26, v37
    v_cvt_pk_bf16_f32 v65, v30, v28
    v_cvt_pk_bf16_f32 v73, v31, v29
    v_mul_f32 v30, v26, v38
    v_mul_f32 v31, v27, v38
    v_fma_f32 v30, -v27, v39, v30
    v_fmac_f32 v31, v26, v39
    v_mul_f32 v28, v26, v40
    v_mul_f32 v29, v27, v40
    v_fma_f32 v28, -v27, v41, v28
    v_fmac_f32 v29, v26, v41
    v_cvt_pk_bf16_f32 v66, v30, v28
    v_cvt_pk_bf16_f32 v74, v31, v29
    v_mul_f32 v30, v26, v42
    v_mul_f32 v31, v27, v42
    v_fma_f32 v30, -v27, v43, v30
    v_fmac_f32 v31, v26, v43
    v_mul_f32 v28, v26, v44
    v_mul_f32 v29, v27, v44
    v_fma_f32 v28, -v27, v45, v28
    v_fmac_f32 v29, v26, v45
    v_cvt_pk_bf16_f32 v67, v30, v28
    v_cvt_pk_bf16_f32 v75, v31, v29
    v_cvt_pk_bf16_f32 v126, v126, v127
    v_cvt_pk_bf16_f32 v127, v128, v129
    v_cvt_pk_bf16_f32 v130, v130, v131
    v_cvt_pk_bf16_f32 v131, v132, v133
    v_cvt_pk_bf16_f32 v134, v134, v135
    v_cvt_pk_bf16_f32 v135, v136, v137
    v_cvt_pk_bf16_f32 v138, v138, v139
    v_cvt_pk_bf16_f32 v139, v140, v141
    v_cvt_pk_bf16_f32 v128, v142, v143
    v_cvt_pk_bf16_f32 v129, v144, v145
    v_cvt_pk_bf16_f32 v132, v146, v147
    v_cvt_pk_bf16_f32 v133, v148, v149
    v_cvt_pk_bf16_f32 v136, v150, v151
    v_cvt_pk_bf16_f32 v137, v152, v153
    v_cvt_pk_bf16_f32 v140, v154, v155
    v_cvt_pk_bf16_f32 v141, v156, v157
    v_mul_f32 v46, v26, v26
    v_mul_f32 v47, v27, v26
    v_fma_f32 v46, -v27, v27, v46
    v_fmac_f32 v47, v26, v27
    v_mfma_f32_16x16x32_bf16 v[50:53], v[126:129], v[80:83], 0
    v_mfma_f32_16x16x32_bf16 v[50:53], v[130:133], v[84:87], v[50:53]
    v_mfma_f32_16x16x32_bf16 v[50:53], v[134:137], v[88:91], v[50:53]
    v_mfma_f32_16x16x32_bf16 v[50:53], v[138:141], v[92:95], v[50:53]
    v_mfma_f32_32x32x16_bf16 v[126:141], v[64:67], v[158:161], 0
    v_mfma_f32_32x32x16_bf16 v[142:157], v[72:75], v[158:161], 0
    v_mul_f32 v28, v46, v34
    v_mul_f32 v29, v47, v34
    v_fma_f32 v28, -v47, v35, v28
    v_fmac_f32 v29, v46, v35
    v_cvt_pk_bf16_f32 v68, v46, v28
    v_cvt_pk_bf16_f32 v76, v47, v29
    v_mul_f32 v30, v46, v38
    v_mul_f32 v31, v47, v38
    v_fma_f32 v30, -v47, v39, v30
    v_fmac_f32 v31, v46, v39
    v_mul_f32 v28, v46, v42
    v_mul_f32 v29, v47, v42
    v_fma_f32 v28, -v47, v43, v28
    v_fmac_f32 v29, v46, v43
    v_cvt_pk_bf16_f32 v69, v30, v28
    v_cvt_pk_bf16_f32 v77, v31, v29
    v_mul_f32 v48, v46, v26
    v_mul_f32 v49, v47, v26
    v_fma_f32 v48, -v47, v27, v48
    v_fmac_f32 v49, v46, v27
    v_mul_f32 v28, v48, v34
    v_mul_f32 v29, v49, v34
    v_fma_f32 v28, -v49, v35, v28
    v_fmac_f32 v29, v48, v35
    v_cvt_pk_bf16_f32 v70, v48, v28
    v_cvt_pk_bf16_f32 v78, v49, v29
    v_mul_f32 v30, v48, v38
    v_mul_f32 v31, v49, v38
    v_fma_f32 v30, -v49, v39, v30
    v_fmac_f32 v31, v48, v39
    v_mul_f32 v28, v48, v42
    v_mul_f32 v29, v49, v42
    v_fma_f32 v28, -v49, v43, v28
    v_fmac_f32 v29, v48, v43
    v_cvt_pk_bf16_f32 v71, v30, v28
    v_cvt_pk_bf16_f32 v79, v31, v29
    v_mul_f32 v46, v48, v26
    v_mul_f32 v47, v49, v26
    v_fma_f32 v46, -v49, v27, v46
    v_fmac_f32 v47, v48, v27
    v_mfma_f32_32x32x16_bf16 v[126:141], v[68:71], v[162:165], v[126:141]
    v_mfma_f32_32x32x16_bf16 v[142:157], v[76:79], v[162:165], v[142:157]
    v_mul_f32 v28, v46, v38
    v_mul_f32 v29, v47, v38
    v_fma_f32 v28, -v47, v39, v28
    v_fmac_f32 v29, v46, v39
    v_cvt_pk_bf16_f32 v64, v46, v28
    v_cvt_pk_bf16_f32 v72, v47, v29
    v_mul_f32 v48, v46, v26
    v_mul_f32 v49, v47, v26
    v_fma_f32 v48, -v47, v27, v48
    v_fmac_f32 v49, v46, v27
    v_mul_f32 v28, v48, v38
    v_mul_f32 v29, v49, v38
    v_fma_f32 v28, -v49, v39, v28
    v_fmac_f32 v29, v48, v39
    v_cvt_pk_bf16_f32 v65, v48, v28
    v_cvt_pk_bf16_f32 v73, v49, v29
    v_mul_f32 v46, v48, v26
    v_mul_f32 v47, v49, v26
    v_fma_f32 v46, -v49, v27, v46
    v_fmac_f32 v47, v48, v27
    v_mul_f32 v28, v46, v38
    v_mul_f32 v29, v47, v38
    v_fma_f32 v28, -v47, v39, v28
    v_fmac_f32 v29, v46, v39
    v_cvt_pk_bf16_f32 v66, v46, v28
    v_cvt_pk_bf16_f32 v74, v47, v29
    v_mul_f32 v48, v46, v26
    v_mul_f32 v49, v47, v26
    v_fma_f32 v48, -v47, v27, v48
    v_fmac_f32 v49, v46, v27
    v_mul_f32 v28, v48, v38
    v_mul_f32 v29, v49, v38
    v_fma_f32 v28, -v49, v39, v28
    v_fmac_f32 v29, v48, v39
    v_cvt_pk_bf16_f32 v67, v48, v28
    v_cvt_pk_bf16_f32 v75, v49, v29
    v_mul_f32 v46, v48, v26
    v_mul_f32 v47, v49, v26
    v_fma_f32 v46, -v49, v27, v46
    v_fmac_f32 v47, v48, v27
    v_cvt_pk_bf16_f32 v126, v126, v127
    v_cvt_pk_bf16_f32 v127, v128, v129
    v_cvt_pk_bf16_f32 v130, v130, v131
    v_cvt_pk_bf16_f32 v131, v132, v133
    v_cvt_pk_bf16_f32 v134, v134, v135
    v_cvt_pk_bf16_f32 v135, v136, v137
    v_cvt_pk_bf16_f32 v138, v138, v139
    v_cvt_pk_bf16_f32 v139, v140, v141
    v_cvt_pk_bf16_f32 v128, v142, v143
    v_cvt_pk_bf16_f32 v129, v144, v145
    v_cvt_pk_bf16_f32 v132, v146, v147
    v_cvt_pk_bf16_f32 v133, v148, v149
    v_cvt_pk_bf16_f32 v136, v150, v151
    v_cvt_pk_bf16_f32 v137, v152, v153
    v_cvt_pk_bf16_f32 v140, v154, v155
    v_cvt_pk_bf16_f32 v141, v156, v157
    v_cvt_pk_bf16_f32 v68, v46, v46
    v_cvt_pk_bf16_f32 v76, v47, v47
    v_mfma_f32_16x16x32_bf16 v[54:57], v[126:129], v[80:83], 0
    v_mfma_f32_16x16x32_bf16 v[54:57], v[130:133], v[84:87], v[54:57]
    v_mfma_f32_16x16x32_bf16 v[54:57], v[134:137], v[88:91], v[54:57]
    v_mfma_f32_16x16x32_bf16 v[54:57], v[138:141], v[92:95], v[54:57]
    v_mfma_f32_32x32x16_bf16 v[126:141], v[64:67], v[158:161], 0
    v_mfma_f32_32x32x16_bf16 v[142:157], v[72:75], v[158:161], 0
    v_mfma_f32_32x32x16_bf16 v[126:141], v[68:71], v[162:165], v[126:141]
    v_mfma_f32_32x32x16_bf16 v[142:157], v[76:79], v[162:165], v[142:157]
L_s_tag_28:
    ds_read_b64 v[2:3], v9 offset:8
    s_add_u32 s66, s66, 0x1000
    s_cbranch_scc1 L_end
    s_waitcnt lgkmcnt(0)
    v_readfirstlane_b32 s9, v3
    v_readfirstlane_b32 s62, v2
    s_cmp_eq_u32 s9, 0
    s_cbranch_scc1 L_s_tag_28
    s_mov_b32 s63, s62
    v_mov_b32 v1, v123
    v_mov_b32 v2, v124
    v_mov_b32 v24, v15
    v_mov_b32 v21, v118
    s_nop 1
    v_cvt_pk_bf16_f32 v126, v126, v127
    v_cvt_pk_bf16_f32 v127, v128, v129
    v_cvt_pk_bf16_f32 v130, v130, v131
    v_cvt_pk_bf16_f32 v131, v132, v133
    v_cvt_pk_bf16_f32 v134, v134, v135
    v_cvt_pk_bf16_f32 v135, v136, v137
    v_cvt_pk_bf16_f32 v138, v138, v139
    v_cvt_pk_bf16_f32 v139, v140, v141
    v_cvt_pk_bf16_f32 v128, v142, v143
    v_cvt_pk_bf16_f32 v129, v144, v145
    v_cvt_pk_bf16_f32 v132, v146, v147
    v_cvt_pk_bf16_f32 v133, v148, v149
    v_cvt_pk_bf16_f32 v136, v150, v151
    v_cvt_pk_bf16_f32 v137, v152, v153
    v_cvt_pk_bf16_f32 v140, v154, v155
    v_cvt_pk_bf16_f32 v141, v156, v157
    s_cmp_eq_u32 s53, 0
    s_cselect_b32 s15, s15, 0
    v_mfma_f32_16x16x32_bf16 v[58:61], v[126:129], v[80:83], 0
    v_mfma_f32_16x16x32_bf16 v[58:61], v[130:133], v[84:87], v[58:61]
    v_mfma_f32_16x16x32_bf16 v[58:61], v[134:137], v[88:91], v[58:61]
    v_mfma_f32_16x16x32_bf16 v[58:61], v[138:141], v[92:95], v[58:61]
    v_mov_b32 v6, 0
    v_mov_b32 v7, 0
    v_writelane_b32 v6, s15, 0
    v_fmac_f32 v50, 0x1f800000, v6
    s_waitcnt vmcnt(0)
    v_mov_b32 v22, v98
    v_mov_b32 v23, v99
    v_lshlrev_b32 v3, 3, v2
    v_sub_u32 v3, v1, v3
    v_mov_b32 v16, 0x3f80
    v_mov_b32 v17, 0x3f800000
    v_add_u32 v18, 11, v3
    v_add_u32 v19, 10, v3
    v_cmp_gt_u32 vcc, 7, v18
    v_cmp_gt_u32 s[10:11], 7, v19
    s_nop 0
    v_cndmask_b32 v18, 0, v16, vcc
    v_cndmask_b32 v19, 0, v17, s[10:11]
    v_or_b32 v156, v18, v19
    v_add_u32 v18, 9, v3
    v_add_u32 v19, 8, v3
    v_cmp_gt_u32 vcc, 7, v18
    v_cmp_gt_u32 s[10:11], 7, v19
    s_nop 0
    v_cndmask_b32 v18, 0, v16, vcc
    v_cndmask_b32 v19, 0, v17, s[10:11]
    v_or_b32 v157, v18, v19
    v_add_u32 v18, 7, v3
    v_add_u32 v19, 6, v3
    v_cmp_gt_u32 vcc, 7, v18
    v_cmp_gt_u32 s[10:11], 7, v19
    s_nop 0
    v_cndmask_b32 v18, 0, v16, vcc
    v_cndmask_b32 v19, 0, v17, s[10:11]
    v_or_b32 v158, v18, v19
    v_add_u32 v18, 5, v3
    v_add_u32 v19, 4, v3
    v_cmp_gt_u32 vcc, 7, v18
    v_cmp_gt_u32 s[10:11], 7, v19
    s_nop 0
    v_cndmask_b32 v18, 0, v16, vcc
    v_cndmask_b32 v19, 0, v17, s[10:11]
    v_or_b32 v159, v18, v19
    v_add_u32 v18, 12, v3
    v_add_u32 v19, 11, v3
    v_cmp_gt_u32 vcc, 9, v18
    v_cmp_gt_u32 s[10:11], 9, v19
    s_nop 0
    v_cndmask_b32 v18, 0, v16, vcc
    v_cndmask_b32 v19, 0, v17, s[10:11]
    v_or_b32 v160, v18, v19
    v_add_u32 v18, 10, v3
    v_add_u32 v19, 9, v3
    v_cmp_gt_u32 vcc, 9, v18
    v_cmp_gt_u32 s[10:11], 9, v19
    s_nop 0
    v_cndmask_b32 v18, 0, v16, vcc
    v_cndmask_b32 v19, 0, v17, s[10:11]
    v_or_b32 v161, v18, v19
    v_add_u32 v18, 8, v3
    v_add_u32 v19, 7, v3
    v_cmp_gt_u32 vcc, 9, v18
    v_cmp_gt_u32 s[10:11], 9, v19
    s_nop 0
    v_cndmask_b32 v18, 0, v16, vcc
    v_cndmask_b32 v19, 0, v17, s[10:11]
    v_or_b32 v162, v18, v19
    v_add_u32 v18, 6, v3
    v_add_u32 v19, 5, v3
    v_cmp_gt_u32 vcc, 9, v18
    v_cmp_gt_u32 s[10:11], 9, v19
    s_nop 0
    v_cndmask_b32 v18, 0, v16, vcc
    v_cndmask_b32 v19, 0, v17, s[10:11]
    v_or_b32 v163, v18, v19
    s_lshl_b32 s10, s2, 13
    s_lshl_b32 s11, s52, 12
    s_add_u32 s10, s10, s11
    s_add_u32 s54, s10, 0x800000
    v_and_b32 v3, 7, v0
    v_lshlrev_b32 v6, 4, v3
    v_lshl_add_u32 v6, v2, 7, v6
    v_bfe_u32 v4, v0, 3, 1
    v_lshl_add_u32 v6, v4, 9, v6
    s_and_b32 s11, s62, 1
    s_sub_u32 s11, 0, s11
    s_xor_b32 s57, s11, 0x69969669
    s_mov_b32 s56, 0xbfffbfff
    v_lshrrev_b32 v3, v3, s57
    v_and_b32 v3, 1, v3
    v_mul_u32_u24 v3, 0x4000, v3
    v_lshl_or_b32 v15, v3, 16, v3
    s_lshl_b32 s58, s60, 12
    s_add_u32 s58, s58, 131072
    s_setprio 3
    s_branch L_s_lp_30
L_s_lp_29:
    s_sleep 2
L_s_lp_30:
    ds_read_b32 v10, v62 offset:16
    s_add_u32 s66, s66, 0x1000
    s_cbranch_scc1 L_end
    s_waitcnt lgkmcnt(0)
    v_cmp_gt_u32 vcc, v63, v10
    s_cbranch_vccnz L_s_lp_29
    ds_write2_b32 v120, v50, v51 offset0:0 offset1:1
    ds_write2_b32 v120, v52, v53 offset0:2 offset1:3
    ds_write2_b32 v121, v54, v55 offset0:0 offset1:1
    ds_write2_b32 v121, v56, v57 offset0:2 offset1:3
    s_mov_b32 exec_hi, 1
    ds_write2_b32 v122, v58, v59 offset0:0 offset1:1
    s_mov_b32 exec_hi, 0
    ds_write2_b32 v122, v60, v61 offset0:33 offset1:34
    s_mov_b64 exec, 1
    ds_write_b32 v125, v7 offset:2720
    ds_add_u32 v9, v8 offset:4
    s_mov_b64 exec, -1
L_s_ks_31:
    ds_read_b32 v10, v9 offset:4
    s_add_u32 s66, s66, 0x1000
    s_cbranch_scc1 L_end
    s_waitcnt lgkmcnt(0)
    v_cmp_gt_u32 vcc, 4, v10
    s_cbranch_vccnz L_s_ks_31
    ds_read2st64_b32 v[126:127], v100 offset0:0 offset1:11
    ds_read2st64_b32 v[128:129], v101 offset0:0 offset1:11
    ds_read2st64_b32 v[130:131], v102 offset0:0 offset1:11
    ds_read2st64_b32 v[132:133], v103 offset0:0 offset1:11
    ds_read2st64_b32 v[134:135], v104 offset0:0 offset1:11
    ds_read2st64_b32 v[136:137], v105 offset0:0 offset1:11
    ds_read2st64_b32 v[138:139], v106 offset0:0 offset1:11
    ds_read2st64_b32 v[140:141], v107 offset0:0 offset1:11
    ds_read2st64_b32 v[142:143], v108 offset0:0 offset1:11
    ds_read2st64_b32 v[144:145], v109 offset0:0 offset1:11
    ds_read2st64_b32 v[146:147], v110 offset0:0 offset1:11
    ds_read2st64_b32 v[148:149], v111 offset0:0 offset1:11
    ds_read2st64_b32 v[150:151], v112 offset0:0 offset1:11
    s_waitcnt lgkmcnt(9)
    v_add_f32 v126, v126, v127
    v_add_f32 v128, v128, v129
    v_add_f32 v130, v130, v131
    v_add_f32 v132, v132, v133
    s_waitcnt lgkmcnt(4)
    v_add_f32 v134, v134, v135
    v_add_f32 v136, v136, v137
    v_add_f32 v138, v138, v139
    v_add_f32 v140, v140, v141
    v_add_f32 v142, v142, v143
    s_waitcnt lgkmcnt(0)
    v_add_f32 v144, v144, v145
    v_add_f32 v146, v146, v147
    v_add_f32 v148, v148, v149
    v_add_f32 v150, v150, v151
    v_cvt_pk_bf16_f32 v32, v126, v128
    v_cvt_pk_bf16_f32 v33, v130, v132
    v_cvt_pk_bf16_f32 v34, v134, v136
    v_cvt_pk_bf16_f32 v35, v138, v140
    ds_write_b128 v12, v[32:35] offset:0
    v_cvt_pk_bf16_f32 v36, v128, v130
    v_cvt_pk_bf16_f32 v37, v132, v134
    v_cvt_pk_bf16_f32 v38, v136, v138
    v_cvt_pk_bf16_f32 v39, v140, v142
    ds_write_b128 v12, v[36:39] offset:2240
    v_cvt_pk_bf16_f32 v40, v130, v132
    v_cvt_pk_bf16_f32 v41, v134, v136
    v_cvt_pk_bf16_f32 v42, v138, v140
    v_cvt_pk_bf16_f32 v43, v142, v144
    ds_write_b128 v12, v[40:43] offset:4480
    v_cvt_pk_bf16_f32 v44, v132, v134
    v_cvt_pk_bf16_f32 v45, v136, v138
    v_cvt_pk_bf16_f32 v46, v140, v142
    v_cvt_pk_bf16_f32 v47, v144, v146
    ds_write_b128 v12, v[44:47] offset:6720
    s_cmp_eq_u32 s53, 0
    s_cbranch_scc1 L_s_g0
    v_cvt_pk_bf16_f32 v48, v148, v150
    ds_write_b32 v11, v48 offset:8960
    s_branch L_s_gj
L_s_g0:
    v_readfirstlane_b32 s10, v32
    v_readfirstlane_b32 s11, v36
    s_nop 0
    s_and_b32 s12, s10, 0xffff0000
    v_mov_b32 v48, s10
    v_mov_b32 v49, s10
    v_mov_b32 v50, s10
    v_mov_b32 v51, s10
    v_writelane_b32 v48, 0, 0
    v_writelane_b32 v48, 0, 1
    v_writelane_b32 v48, s12, 2
    v_writelane_b32 v49, s12, 0
    v_writelane_b32 v51, s11, 3
    s_mov_b64 exec, 15
    ds_write_b128 v119, v[48:51] offset:48
    s_mov_b64 exec, -1
L_s_gj:
    s_mov_b64 exec, 1
    ds_add_u32 v9, v8 offset:0
    s_mov_b64 exec, -1
L_sb_33:
    ds_read_b32 v10, v96 offset:0
    s_add_u32 s66, s66, 0x1000
    s_cbranch_scc1 L_end
    s_waitcnt lgkmcnt(0)
    v_cmp_gt_u32 vcc, v97, v10
    s_cbranch_vccnz L_sb_33
    s_setprio 2
    s_cmp_eq_u32 s53, 0
    s_cbranch_scc1 L_s_x0
    ds_read_b64 v[36:37], v24 offset:2048
    ds_read_b64 v[38:39], v24 offset:2056
    ds_read_b128 v[64:67], v14 offset:3008
    ds_read_b128 v[68:71], v14 offset:3520
    ds_read_b128 v[72:75], v14 offset:4032
    ds_read_b64 v[40:41], v24 offset:1536
    ds_read_b64 v[42:43], v24 offset:1544
    ds_read_b128 v[60:63], v14 offset:2496
    ds_read_b64 v[44:45], v24 offset:1024
    ds_read_b64 v[46:47], v24 offset:1032
    ds_read_b128 v[56:59], v14 offset:1984
    ds_read_b64 v[48:49], v24 offset:512
    ds_read_b64 v[50:51], v24 offset:520
    ds_read_b128 v[52:55], v14 offset:1472
    ds_read_b64 v[76:77], v24 offset:1984
    s_waitcnt lgkmcnt(12)
    v_mfma_f32_16x16x32_bf16 v[28:31], v[64:67], v[36:39], 0
    ds_read_b64 v[78:79], v24 offset:1992
    ds_read_b128 v[104:107], v14 offset:2944
    s_waitcnt lgkmcnt(9)
    v_mfma_f32_16x16x32_bf16 v[32:35], v[68:71], v[36:39], 0
    ds_read_b128 v[108:111], v14 offset:3456
    ds_read_b128 v[112:115], v14 offset:3968
    v_mfma_f32_16x16x32_bf16 v[16:19], v[72:75], v[36:39], 0
    ds_read_b64 v[80:81], v24 offset:1472
    ds_read_b64 v[82:83], v24 offset:1480
    v_mfma_f32_16x16x32_bf16 v[28:31], v[60:63], v[40:43], v[28:31]
    ds_read_b128 v[100:103], v14 offset:2432
    ds_read_b64 v[84:85], v24 offset:960
    v_mfma_f32_16x16x32_bf16 v[32:35], v[64:67], v[40:43], v[32:35]
    v_mfma_f32_16x16x32_bf16 v[16:19], v[68:71], v[40:43], v[16:19]
    s_waitcnt lgkmcnt(12)
    v_mfma_f32_16x16x32_bf16 v[28:31], v[56:59], v[44:47], v[28:31]
    ds_read_b64 v[86:87], v24 offset:968
    ds_read_b128 v[96:99], v14 offset:1920
    v_mfma_f32_16x16x32_bf16 v[32:35], v[60:63], v[44:47], v[32:35]
    ds_read_b64 v[88:89], v24 offset:448
    v_mfma_f32_16x16x32_bf16 v[16:19], v[64:67], v[44:47], v[16:19]
    s_waitcnt lgkmcnt(12)
    v_mfma_f32_16x16x32_bf16 v[28:31], v[52:55], v[48:51], v[28:31]
    ds_read_b64 v[90:91], v24 offset:456
    ds_read_b128 v[92:95], v14 offset:1408
    v_mfma_f32_16x16x32_bf16 v[32:35], v[56:59], v[48:51], v[32:35]
    ds_read_b64 v[136:137], v24 offset:0
    v_mfma_f32_16x16x32_bf16 v[16:19], v[60:63], v[48:51], v[16:19]
    s_waitcnt lgkmcnt(10)
    v_mfma_f32_16x16x32_bf16 v[28:31], v[104:107], v[76:79], v[28:31]
    ds_read_b64 v[138:139], v24 offset:8
    ds_read_b128 v[120:123], v14 offset:448
    v_mfma_f32_16x16x32_bf16 v[32:35], v[108:111], v[76:79], v[32:35]
    ds_read_b128 v[140:143], v14 offset:432
    ds_read_b128 v[124:127], v14 offset:960
    v_mfma_f32_16x16x32_bf16 v[16:19], v[112:115], v[76:79], v[16:19]
    ds_read_b128 v[144:147], v14 offset:944
    s_waitcnt lgkmcnt(12)
    v_mfma_f32_16x16x32_bf16 v[28:31], v[100:103], v[80:83], v[28:31]
    ds_read_b128 v[128:131], v14 offset:1472
    ds_read_b128 v[148:151], v14 offset:1456
    v_mfma_f32_16x16x32_bf16 v[32:35], v[104:107], v[80:83], v[32:35]
    ds_read_b128 v[132:135], v14 offset:1984
    v_mfma_f32_16x16x32_bf16 v[16:19], v[108:111], v[80:83], v[16:19]
    s_waitcnt lgkmcnt(12)
    v_mfma_f32_16x16x32_bf16 v[28:31], v[96:99], v[84:87], v[28:31]
    ds_read_b128 v[152:155], v14 offset:1968
    ds_read_b64 v[36:37], v24 offset:1920
    v_mfma_f32_16x16x32_bf16 v[32:35], v[100:103], v[84:87], v[32:35]
    ds_read_b64 v[38:39], v24 offset:1928
    v_mfma_f32_16x16x32_bf16 v[16:19], v[104:107], v[84:87], v[16:19]
    s_waitcnt lgkmcnt(12)
    v_mfma_f32_16x16x32_bf16 v[28:31], v[92:95], v[88:91], v[28:31]
    ds_read_b128 v[64:67], v14 offset:2880
    ds_read_b128 v[68:71], v14 offset:3392
    v_mfma_f32_16x16x32_bf16 v[32:35], v[96:99], v[88:91], v[32:35]
    ds_read_b128 v[72:75], v14 offset:3904
    v_mfma_f32_16x16x32_bf16 v[16:19], v[100:103], v[88:91], v[16:19]
    s_waitcnt lgkmcnt(9)
    v_mfma_f32_16x16x32_bf16 v[28:31], v[124:127], v[136:139], v[28:31]
    ds_read_b64 v[40:41], v24 offset:1408
    ds_read_b64 v[42:43], v24 offset:1416
    s_waitcnt lgkmcnt(7)
    v_mfma_f32_16x16x32_bf16 v[32:35], v[128:131], v[136:139], v[32:35]
    ds_read_b128 v[60:63], v14 offset:2368
    ds_read_b64 v[44:45], v24 offset:896
    v_mfma_f32_16x16x32_bf16 v[16:19], v[132:135], v[136:139], v[16:19]
    ds_read_b64 v[46:47], v24 offset:904
    ds_read_b128 v[56:59], v14 offset:1856
    v_mfma_f32_16x16x32_bf16 v[116:119], v[120:123], v[156:159], 0
    ds_read_b64 v[48:49], v24 offset:384
    ds_read_b64 v[50:51], v24 offset:392
    v_mfma_f32_16x16x32_bf16 v[136:139], v[140:143], v[160:163], 0
    ds_read_b128 v[52:55], v14 offset:1344
    v_mfma_f32_16x16x32_bf16 v[120:123], v[124:127], v[156:159], 0
    v_mfma_f32_16x16x32_bf16 v[140:143], v[144:147], v[160:163], 0
    v_mfma_f32_16x16x32_bf16 v[124:127], v[128:131], v[156:159], 0
    v_mfma_f32_16x16x32_bf16 v[144:147], v[148:151], v[160:163], 0
    v_mfma_f32_16x16x32_bf16 v[128:131], v[132:135], v[156:159], 0
    v_mfma_f32_16x16x32_bf16 v[148:151], v[152:155], v[160:163], 0
    ds_read_b64 v[76:77], v24 offset:1856
    s_waitcnt lgkmcnt(10)
    v_mfma_f32_16x16x32_bf16 v[28:31], v[64:67], v[36:39], v[28:31]
    ds_read_b64 v[78:79], v24 offset:1864
    ds_read_b128 v[104:107], v14 offset:2816
    v_mfma_f32_16x16x32_bf16 v[32:35], v[68:71], v[36:39], v[32:35]
    ds_read_b128 v[108:111], v14 offset:3328
    ds_read_b128 v[112:115], v14 offset:3840
    v_mfma_f32_16x16x32_bf16 v[16:19], v[72:75], v[36:39], v[16:19]
    ds_read_b64 v[80:81], v24 offset:1344
    s_waitcnt lgkmcnt(12)
    v_mfma_f32_16x16x32_bf16 v[28:31], v[60:63], v[40:43], v[28:31]
    ds_read_b64 v[82:83], v24 offset:1352
    ds_read_b128 v[100:103], v14 offset:2304
    v_mfma_f32_16x16x32_bf16 v[32:35], v[64:67], v[40:43], v[32:35]
    ds_read_b64 v[84:85], v24 offset:832
    v_mfma_f32_16x16x32_bf16 v[16:19], v[68:71], v[40:43], v[16:19]
    s_waitcnt lgkmcnt(12)
    v_mfma_f32_16x16x32_bf16 v[28:31], v[56:59], v[44:47], v[28:31]
    ds_read_b64 v[86:87], v24 offset:840
    ds_read_b128 v[96:99], v14 offset:1792
    v_mfma_f32_16x16x32_bf16 v[32:35], v[60:63], v[44:47], v[32:35]
    ds_read_b64 v[88:89], v24 offset:320
    v_mfma_f32_16x16x32_bf16 v[16:19], v[64:67], v[44:47], v[16:19]
    s_waitcnt lgkmcnt(12)
    v_mfma_f32_16x16x32_bf16 v[28:31], v[52:55], v[48:51], v[28:31]
    ds_read_b64 v[90:91], v24 offset:328
    ds_read_b128 v[92:95], v14 offset:1280
    v_mfma_f32_16x16x32_bf16 v[32:35], v[56:59], v[48:51], v[32:35]
    v_mfma_f32_16x16x32_bf16 v[16:19], v[60:63], v[48:51], v[16:19]
    v_cvt_pk_bf16_f32 v116, v116, v136
    v_cvt_pk_bf16_f32 v117, v117, v137
    v_cvt_pk_bf16_f32 v118, v118, v138
    v_cvt_pk_bf16_f32 v119, v119, v139
    v_cvt_pk_bf16_f32 v120, v120, v140
    v_cvt_pk_bf16_f32 v121, v121, v141
    v_cvt_pk_bf16_f32 v122, v122, v142
    v_cvt_pk_bf16_f32 v123, v123, v143
    v_cvt_pk_bf16_f32 v124, v124, v144
    v_cvt_pk_bf16_f32 v125, v125, v145
    v_cvt_pk_bf16_f32 v126, v126, v146
    v_cvt_pk_bf16_f32 v127, v127, v147
    v_cvt_pk_bf16_f32 v128, v128, v148
    v_cvt_pk_bf16_f32 v129, v129, v149
    v_cvt_pk_bf16_f32 v130, v130, v150
    v_cvt_pk_bf16_f32 v131, v131, v151
    ds_read_b64 v[36:37], v24 offset:1792
    s_waitcnt lgkmcnt(10)
    v_mfma_f32_16x16x32_bf16 v[28:31], v[104:107], v[76:79], v[28:31]
    ds_read_b64 v[38:39], v24 offset:1800
    ds_read_b128 v[64:67], v14 offset:2752
    v_mfma_f32_16x16x32_bf16 v[32:35], v[108:111], v[76:79], v[32:35]
    ds_read_b128 v[68:71], v14 offset:3264
    ds_read_b128 v[72:75], v14 offset:3776
    v_mfma_f32_16x16x32_bf16 v[16:19], v[112:115], v[76:79], v[16:19]
    ds_read_b64 v[40:41], v24 offset:1280
    s_waitcnt lgkmcnt(12)
    v_mfma_f32_16x16x32_bf16 v[28:31], v[100:103], v[80:83], v[28:31]
    ds_read_b64 v[42:43], v24 offset:1288
    ds_read_b128 v[60:63], v14 offset:2240
    v_mfma_f32_16x16x32_bf16 v[32:35], v[104:107], v[80:83], v[32:35]
    ds_read_b64 v[44:45], v24 offset:768
    v_mfma_f32_16x16x32_bf16 v[16:19], v[108:111], v[80:83], v[16:19]
    s_waitcnt lgkmcnt(12)
    v_mfma_f32_16x16x32_bf16 v[28:31], v[96:99], v[84:87], v[28:31]
    ds_read_b64 v[46:47], v24 offset:776
    ds_read_b128 v[56:59], v14 offset:1728
    v_mfma_f32_16x16x32_bf16 v[32:35], v[100:103], v[84:87], v[32:35]
    ds_read_b64 v[48:49], v24 offset:256
    v_mfma_f32_16x16x32_bf16 v[16:19], v[104:107], v[84:87], v[16:19]
    s_waitcnt lgkmcnt(12)
    v_mfma_f32_16x16x32_bf16 v[28:31], v[92:95], v[88:91], v[28:31]
    ds_read_b64 v[50:51], v24 offset:264
    ds_read_b128 v[52:55], v14 offset:1216
    v_mfma_f32_16x16x32_bf16 v[32:35], v[96:99], v[88:91], v[32:35]
    ds_read2_b32 v[140:141], v21 offset0:48 offset1:49
    v_mfma_f32_16x16x32_bf16 v[16:19], v[100:103], v[88:91], v[16:19]
    s_waitcnt lgkmcnt(10)
    v_mfma_f32_16x16x32_bf16 v[28:31], v[64:67], v[36:39], v[28:31]
    ds_read2_b32 v[142:143], v21 offset0:50 offset1:51
    ds_read2_b32 v[144:145], v21 offset0:32 offset1:33
    v_mfma_f32_16x16x32_bf16 v[32:35], v[68:71], v[36:39], v[32:35]
    ds_read2_b32 v[146:147], v21 offset0:34 offset1:35
    ds_read2_b32 v[148:149], v21 offset0:16 offset1:17
    v_mfma_f32_16x16x32_bf16 v[16:19], v[72:75], v[36:39], v[16:19]
    ds_read2_b32 v[150:151], v21 offset0:18 offset1:19
    s_waitcnt lgkmcnt(12)
    v_mfma_f32_16x16x32_bf16 v[28:31], v[60:63], v[40:43], v[28:31]
    ds_read2_b32 v[152:153], v21 offset0:0 offset1:1
    ds_read2_b32 v[154:155], v21 offset0:2 offset1:3
    v_mfma_f32_16x16x32_bf16 v[32:35], v[64:67], v[40:43], v[32:35]
    ds_read_b64 v[76:77], v24 offset:1728
    v_mfma_f32_16x16x32_bf16 v[16:19], v[68:71], v[40:43], v[16:19]
    s_waitcnt lgkmcnt(12)
    v_mfma_f32_16x16x32_bf16 v[28:31], v[56:59], v[44:47], v[28:31]
    ds_read_b64 v[78:79], v24 offset:1736
    ds_read_b128 v[104:107], v14 offset:2688
    v_mfma_f32_16x16x32_bf16 v[32:35], v[60:63], v[44:47], v[32:35]
    ds_read_b128 v[108:111], v14 offset:3200
    v_mfma_f32_16x16x32_bf16 v[16:19], v[64:67], v[44:47], v[16:19]
    s_waitcnt lgkmcnt(12)
    v_mfma_f32_16x16x32_bf16 v[28:31], v[52:55], v[48:51], v[28:31]
    ds_read_b128 v[112:115], v14 offset:3712
    ds_read_b64 v[80:81], v24 offset:1216
    v_mfma_f32_16x16x32_bf16 v[32:35], v[56:59], v[48:51], v[32:35]
    ds_read_b64 v[82:83], v24 offset:1224
    v_mfma_f32_16x16x32_bf16 v[16:19], v[60:63], v[48:51], v[16:19]
    s_waitcnt lgkmcnt(9)
    v_mfma_f32_16x16x32_bf16 v[28:31], v[144:147], v[116:119], v[28:31]
    ds_read_b128 v[100:103], v14 offset:2176
    ds_read_b64 v[84:85], v24 offset:704
    v_mfma_f32_16x16x32_bf16 v[28:31], v[140:143], v[120:123], v[28:31]
    ds_read_b64 v[86:87], v24 offset:712
    ds_read_b128 v[96:99], v14 offset:1664
    v_mfma_f32_16x16x32_bf16 v[32:35], v[148:151], v[116:119], v[32:35]
    ds_read_b64 v[88:89], v24 offset:192
    ds_read_b64 v[90:91], v24 offset:200
    v_mfma_f32_16x16x32_bf16 v[32:35], v[144:147], v[120:123], v[32:35]
    v_mfma_f32_16x16x32_bf16 v[32:35], v[140:143], v[124:127], v[32:35]
    s_waitcnt lgkmcnt(13)
    v_mfma_f32_16x16x32_bf16 v[16:19], v[152:155], v[116:119], v[16:19]
    ds_read_b128 v[92:95], v14 offset:1152
    v_mfma_f32_16x16x32_bf16 v[16:19], v[148:151], v[120:123], v[16:19]
    v_mfma_f32_16x16x32_bf16 v[16:19], v[144:147], v[124:127], v[16:19]
    v_mfma_f32_16x16x32_bf16 v[16:19], v[140:143], v[128:131], v[16:19]
    ds_read_b64 v[36:37], v24 offset:1664
    s_waitcnt lgkmcnt(10)
    v_mfma_f32_16x16x32_bf16 v[28:31], v[104:107], v[76:79], v[28:31]
    ds_read_b64 v[38:39], v24 offset:1672
    ds_read_b128 v[64:67], v14 offset:2624
    v_mfma_f32_16x16x32_bf16 v[32:35], v[108:111], v[76:79], v[32:35]
    ds_read_b128 v[68:71], v14 offset:3136
    ds_read_b128 v[72:75], v14 offset:3648
    v_mfma_f32_16x16x32_bf16 v[16:19], v[112:115], v[76:79], v[16:19]
    ds_read_b64 v[40:41], v24 offset:1152
    s_waitcnt lgkmcnt(12)
    v_mfma_f32_16x16x32_bf16 v[28:31], v[100:103], v[80:83], v[28:31]
    ds_read_b64 v[42:43], v24 offset:1160
    ds_read_b128 v[60:63], v14 offset:2112
    v_mfma_f32_16x16x32_bf16 v[32:35], v[104:107], v[80:83], v[32:35]
    ds_read_b64 v[44:45], v24 offset:640
    v_mfma_f32_16x16x32_bf16 v[16:19], v[108:111], v[80:83], v[16:19]
    s_waitcnt lgkmcnt(12)
    v_mfma_f32_16x16x32_bf16 v[28:31], v[96:99], v[84:87], v[28:31]
    ds_read_b64 v[46:47], v24 offset:648
    ds_read_b128 v[56:59], v14 offset:1600
    v_mfma_f32_16x16x32_bf16 v[32:35], v[100:103], v[84:87], v[32:35]
    ds_read_b64 v[48:49], v24 offset:128
    v_mfma_f32_16x16x32_bf16 v[16:19], v[104:107], v[84:87], v[16:19]
    s_waitcnt lgkmcnt(12)
    v_mfma_f32_16x16x32_bf16 v[28:31], v[92:95], v[88:91], v[28:31]
    ds_read_b64 v[50:51], v24 offset:136
    ds_read_b128 v[52:55], v14 offset:1088
    v_mfma_f32_16x16x32_bf16 v[32:35], v[96:99], v[88:91], v[32:35]
    v_mfma_f32_16x16x32_bf16 v[16:19], v[100:103], v[88:91], v[16:19]
    ds_read_b64 v[76:77], v24 offset:1600
    s_waitcnt lgkmcnt(10)
    v_mfma_f32_16x16x32_bf16 v[28:31], v[64:67], v[36:39], v[28:31]
    ds_read_b64 v[78:79], v24 offset:1608
    ds_read_b128 v[104:107], v14 offset:2560
    v_mfma_f32_16x16x32_bf16 v[32:35], v[68:71], v[36:39], v[32:35]
    ds_read_b128 v[108:111], v14 offset:3072
    ds_read_b128 v[112:115], v14 offset:3584
    v_mfma_f32_16x16x32_bf16 v[16:19], v[72:75], v[36:39], v[16:19]
    ds_read_b64 v[80:81], v24 offset:1088
    s_waitcnt lgkmcnt(12)
    v_mfma_f32_16x16x32_bf16 v[28:31], v[60:63], v[40:43], v[28:31]
    ds_read_b64 v[82:83], v24 offset:1096
    ds_read_b128 v[100:103], v14 offset:2048
    v_mfma_f32_16x16x32_bf16 v[32:35], v[64:67], v[40:43], v[32:35]
    ds_read_b64 v[84:85], v24 offset:576
    v_mfma_f32_16x16x32_bf16 v[16:19], v[68:71], v[40:43], v[16:19]
    s_waitcnt lgkmcnt(12)
    v_mfma_f32_16x16x32_bf16 v[28:31], v[56:59], v[44:47], v[28:31]
    ds_read_b64 v[86:87], v24 offset:584
    ds_read_b128 v[96:99], v14 offset:1536
    v_mfma_f32_16x16x32_bf16 v[32:35], v[60:63], v[44:47], v[32:35]
    ds_read_b64 v[88:89], v24 offset:64
    v_mfma_f32_16x16x32_bf16 v[16:19], v[64:67], v[44:47], v[16:19]
    s_waitcnt lgkmcnt(12)
    v_mfma_f32_16x16x32_bf16 v[28:31], v[52:55], v[48:51], v[28:31]
    ds_read_b64 v[90:91], v24 offset:72
    ds_read_b128 v[92:95], v14 offset:1024
    v_mfma_f32_16x16x32_bf16 v[32:35], v[56:59], v[48:51], v[32:35]
    v_mfma_f32_16x16x32_bf16 v[16:19], v[60:63], v[48:51], v[16:19]
    s_waitcnt lgkmcnt(9)
    v_mfma_f32_16x16x32_bf16 v[28:31], v[104:107], v[76:79], v[28:31]
    v_mfma_f32_16x16x32_bf16 v[32:35], v[108:111], v[76:79], v[32:35]
    v_mfma_f32_16x16x32_bf16 v[16:19], v[112:115], v[76:79], v[16:19]
    s_waitcnt lgkmcnt(6)
    v_mfma_f32_16x16x32_bf16 v[28:31], v[100:103], v[80:83], v[28:31]
    v_mfma_f32_16x16x32_bf16 v[32:35], v[104:107], v[80:83], v[32:35]
    v_mfma_f32_16x16x32_bf16 v[16:19], v[108:111], v[80:83], v[16:19]
    s_waitcnt lgkmcnt(3)
    v_mfma_f32_16x16x32_bf16 v[28:31], v[96:99], v[84:87], v[28:31]
    v_mfma_f32_16x16x32_bf16 v[32:35], v[100:103], v[84:87], v[32:35]
    v_mfma_f32_16x16x32_bf16 v[16:19], v[104:107], v[84:87], v[16:19]
    s_waitcnt lgkmcnt(0)
    v_mfma_f32_16x16x32_bf16 v[28:31], v[92:95], v[88:91], v[28:31]
    v_mfma_f32_16x16x32_bf16 v[32:35], v[96:99], v[88:91], v[32:35]
    v_mfma_f32_16x16x32_bf16 v[16:19], v[100:103], v[88:91], v[16:19]
    s_nop 5
    v_cvt_pk_bf16_f32 v36, v28, v29
    v_cvt_pk_bf16_f32 v37, v30, v31
    v_cvt_pk_bf16_f32 v38, v32, v33
    v_cvt_pk_bf16_f32 v39, v34, v35
    v_cvt_pk_bf16_f32 v40, v16, v17
    v_cvt_pk_bf16_f32 v41, v18, v19
    v_mov_b32 v48, v36
    v_mov_b32 v49, v37
    v_mov_b32 v50, v40
    v_mov_b32 v51, v41
    v_mov_b32_dpp v36, v38 row_ror:8 row_mask:0xf bank_mask:0xc
    v_mov_b32_dpp v37, v39 row_ror:8 row_mask:0xf bank_mask:0xc
    v_mov_b32_dpp v38, v48 row_ror:8 row_mask:0xf bank_mask:0x3
    v_mov_b32_dpp v39, v49 row_ror:8 row_mask:0xf bank_mask:0x3
    v_and_or_b32 v36, v36, s56, v15
    v_and_or_b32 v37, v37, s56, v15
    v_and_or_b32 v38, v38, s56, v15
    v_and_or_b32 v39, v39, s56, v15
    buffer_store_dwordx4 v[36:39], v6, s[72:75], s54 offen offset:2560 sc1
    v_mov_b32_dpp v42, v50 row_ror:8 row_mask:0xf bank_mask:0x3
    v_mov_b32_dpp v43, v51 row_ror:8 row_mask:0xf bank_mask:0x3
    v_and_or_b32 v40, v40, s56, v15
    v_and_or_b32 v41, v41, s56, v15
    v_and_or_b32 v42, v42, s56, v15
    v_and_or_b32 v43, v43, s56, v15
    s_mov_b32 exec_lo, 0x00ff00ff
    s_mov_b32 exec_hi, exec_lo
    buffer_store_dwordx4 v[40:43], v6, s[72:75], s54 offen offset:3584 sc1
    s_mov_b64 exec, -1
    s_branch L_s_xj
L_s_x0:
    ds_read_b64 v[48:49], v24 offset:2048
    ds_read_b64 v[50:51], v24 offset:2056
    ds_read_b128 v[64:67], v14 offset:448
    ds_read_b128 v[68:71], v14 offset:960
    ds_read_b128 v[72:75], v14 offset:1472
    ds_read_b128 v[76:79], v14 offset:1984
    ds_read_b128 v[80:83], v14 offset:2496
    ds_read_b64 v[52:53], v24 offset:1536
    ds_read_b64 v[54:55], v24 offset:1544
    ds_read_b64 v[56:57], v24 offset:1024
    ds_read_b64 v[58:59], v24 offset:1032
    ds_read_b64 v[60:61], v24 offset:512
    ds_read_b64 v[62:63], v24 offset:520
    ds_read_b64 v[84:85], v24 offset:1984
    ds_read_b64 v[86:87], v24 offset:1992
    s_waitcnt lgkmcnt(12)
    v_mfma_f32_16x16x32_bf16 v[28:31], v[64:67], v[48:51], 0
    ds_read_b128 v[100:103], v14 offset:384
    ds_read_b128 v[104:107], v14 offset:896
    s_waitcnt lgkmcnt(11)
    v_mfma_f32_16x16x32_bf16 v[32:35], v[68:71], v[48:51], 0
    ds_read_b128 v[108:111], v14 offset:1408
    ds_read_b128 v[112:115], v14 offset:1920
    v_mfma_f32_16x16x32_bf16 v[36:39], v[72:75], v[48:51], 0
    ds_read_b128 v[116:119], v14 offset:2432
    ds_read_b64 v[88:89], v24 offset:1472
    v_mfma_f32_16x16x32_bf16 v[40:43], v[76:79], v[48:51], 0
    s_waitcnt lgkmcnt(12)
    v_mfma_f32_16x16x32_bf16 v[44:47], v[80:83], v[48:51], 0
    ds_read_b64 v[90:91], v24 offset:1480
    ds_read_b64 v[92:93], v24 offset:960
    v_mfma_f32_16x16x32_bf16 v[32:35], v[64:67], v[52:55], v[32:35]
    ds_read_b64 v[94:95], v24 offset:968
    v_mfma_f32_16x16x32_bf16 v[36:39], v[68:71], v[52:55], v[36:39]
    v_mfma_f32_16x16x32_bf16 v[40:43], v[72:75], v[52:55], v[40:43]
    v_mfma_f32_16x16x32_bf16 v[44:47], v[76:79], v[52:55], v[44:47]
    s_waitcnt lgkmcnt(13)
    v_mfma_f32_16x16x32_bf16 v[36:39], v[64:67], v[56:59], v[36:39]
    ds_read_b64 v[96:97], v24 offset:448
    ds_read_b64 v[98:99], v24 offset:456
    v_mfma_f32_16x16x32_bf16 v[40:43], v[68:71], v[56:59], v[40:43]
    v_mfma_f32_16x16x32_bf16 v[44:47], v[72:75], v[56:59], v[44:47]
    s_waitcnt lgkmcnt(10)
    v_mfma_f32_16x16x32_bf16 v[40:43], v[64:67], v[60:63], v[40:43]
    ds_read_b64 v[128:129], v24 offset:0
    ds_read_b64 v[130:131], v24 offset:8
    v_mfma_f32_16x16x32_bf16 v[44:47], v[68:71], v[60:63], v[44:47]
    ds_read_b128 v[124:127], v14 offset:448
    ds_read_b128 v[132:135], v14 offset:432
    v_mfma_f32_16x16x32_bf16 v[28:31], v[100:103], v[84:87], v[28:31]
    ds_read_b64 v[48:49], v24 offset:1920
    s_waitcnt lgkmcnt(12)
    v_mfma_f32_16x16x32_bf16 v[32:35], v[104:107], v[84:87], v[32:35]
    ds_read_b64 v[50:51], v24 offset:1928
    ds_read_b128 v[64:67], v14 offset:320
    v_mfma_f32_16x16x32_bf16 v[36:39], v[108:111], v[84:87], v[36:39]
    ds_read_b128 v[68:71], v14 offset:832
    v_mfma_f32_16x16x32_bf16 v[40:43], v[112:115], v[84:87], v[40:43]
    s_waitcnt lgkmcnt(12)
    v_mfma_f32_16x16x32_bf16 v[44:47], v[116:119], v[84:87], v[44:47]
    ds_read_b128 v[72:75], v14 offset:1344
    ds_read_b128 v[76:79], v14 offset:1856
    v_mfma_f32_16x16x32_bf16 v[32:35], v[100:103], v[88:91], v[32:35]
    ds_read_b128 v[80:83], v14 offset:2368
    v_mfma_f32_16x16x32_bf16 v[36:39], v[104:107], v[88:91], v[36:39]
    v_mfma_f32_16x16x32_bf16 v[40:43], v[108:111], v[88:91], v[40:43]
    v_mfma_f32_16x16x32_bf16 v[44:47], v[112:115], v[88:91], v[44:47]
    s_waitcnt lgkmcnt(13)
    v_mfma_f32_16x16x32_bf16 v[36:39], v[100:103], v[92:95], v[36:39]
    ds_read_b64 v[52:53], v24 offset:1408
    ds_read_b64 v[54:55], v24 offset:1416
    v_mfma_f32_16x16x32_bf16 v[40:43], v[104:107], v[92:95], v[40:43]
    v_mfma_f32_16x16x32_bf16 v[44:47], v[108:111], v[92:95], v[44:47]
    s_waitcnt lgkmcnt(9)
    v_mfma_f32_16x16x32_bf16 v[40:43], v[100:103], v[96:99], v[40:43]
    ds_read_b64 v[56:57], v24 offset:896
    ds_read_b64 v[58:59], v24 offset:904
    v_mfma_f32_16x16x32_bf16 v[44:47], v[104:107], v[96:99], v[44:47]
    ds_read_b64 v[60:61], v24 offset:384
    ds_read_b64 v[62:63], v24 offset:392
    v_mfma_f32_16x16x32_bf16 v[44:47], v[124:127], v[128:131], v[44:47]
    v_mfma_f32_16x16x32_bf16 v[120:123], v[124:127], v[156:159], 0
    v_mfma_f32_16x16x32_bf16 v[128:131], v[132:135], v[160:163], 0
    ds_read_b64 v[84:85], v24 offset:1856
    ds_read_b64 v[86:87], v24 offset:1864
    s_waitcnt lgkmcnt(10)
    v_mfma_f32_16x16x32_bf16 v[28:31], v[64:67], v[48:51], v[28:31]
    ds_read_b128 v[100:103], v14 offset:256
    ds_read_b128 v[104:107], v14 offset:768
    v_mfma_f32_16x16x32_bf16 v[32:35], v[68:71], v[48:51], v[32:35]
    ds_read_b128 v[108:111], v14 offset:1280
    ds_read_b128 v[112:115], v14 offset:1792
    v_mfma_f32_16x16x32_bf16 v[36:39], v[72:75], v[48:51], v[36:39]
    ds_read_b128 v[116:119], v14 offset:2304
    s_waitcnt lgkmcnt(11)
    v_mfma_f32_16x16x32_bf16 v[40:43], v[76:79], v[48:51], v[40:43]
    ds_read_b64 v[88:89], v24 offset:1344
    ds_read_b64 v[90:91], v24 offset:1352
    v_mfma_f32_16x16x32_bf16 v[44:47], v[80:83], v[48:51], v[44:47]
    ds_read_b64 v[92:93], v24 offset:832
    ds_read_b64 v[94:95], v24 offset:840
    v_mfma_f32_16x16x32_bf16 v[32:35], v[64:67], v[52:55], v[32:35]
    v_mfma_f32_16x16x32_bf16 v[36:39], v[68:71], v[52:55], v[36:39]
    v_mfma_f32_16x16x32_bf16 v[40:43], v[72:75], v[52:55], v[40:43]
    v_mfma_f32_16x16x32_bf16 v[44:47], v[76:79], v[52:55], v[44:47]
    s_waitcnt lgkmcnt(13)
    v_mfma_f32_16x16x32_bf16 v[36:39], v[64:67], v[56:59], v[36:39]
    ds_read_b64 v[96:97], v24 offset:320
    ds_read_b64 v[98:99], v24 offset:328
    v_mfma_f32_16x16x32_bf16 v[40:43], v[68:71], v[56:59], v[40:43]
    v_mfma_f32_16x16x32_bf16 v[44:47], v[72:75], v[56:59], v[44:47]
    s_waitcnt lgkmcnt(13)
    v_mfma_f32_16x16x32_bf16 v[40:43], v[64:67], v[60:63], v[40:43]
    v_mfma_f32_16x16x32_bf16 v[44:47], v[68:71], v[60:63], v[44:47]
    v_cvt_pk_bf16_f32 v120, v120, v128
    v_cvt_pk_bf16_f32 v121, v121, v129
    v_cvt_pk_bf16_f32 v122, v122, v130
    v_cvt_pk_bf16_f32 v123, v123, v131
    ds_read_b64 v[48:49], v24 offset:1792
    ds_read_b64 v[50:51], v24 offset:1800
    s_waitcnt lgkmcnt(10)
    v_mfma_f32_16x16x32_bf16 v[28:31], v[100:103], v[84:87], v[28:31]
    ds_read_b128 v[64:67], v14 offset:192
    ds_read_b128 v[68:71], v14 offset:704
    v_mfma_f32_16x16x32_bf16 v[32:35], v[104:107], v[84:87], v[32:35]
    ds_read_b128 v[72:75], v14 offset:1216
    ds_read_b128 v[76:79], v14 offset:1728
    v_mfma_f32_16x16x32_bf16 v[36:39], v[108:111], v[84:87], v[36:39]
    ds_read_b128 v[80:83], v14 offset:2240
    s_waitcnt lgkmcnt(11)
    v_mfma_f32_16x16x32_bf16 v[40:43], v[112:115], v[84:87], v[40:43]
    ds_read_b64 v[52:53], v24 offset:1280
    ds_read_b64 v[54:55], v24 offset:1288
    v_mfma_f32_16x16x32_bf16 v[44:47], v[116:119], v[84:87], v[44:47]
    ds_read_b64 v[56:57], v24 offset:768
    ds_read_b64 v[58:59], v24 offset:776
    v_mfma_f32_16x16x32_bf16 v[32:35], v[100:103], v[88:91], v[32:35]
    v_mfma_f32_16x16x32_bf16 v[36:39], v[104:107], v[88:91], v[36:39]
    v_mfma_f32_16x16x32_bf16 v[40:43], v[108:111], v[88:91], v[40:43]
    v_mfma_f32_16x16x32_bf16 v[44:47], v[112:115], v[88:91], v[44:47]
    s_waitcnt lgkmcnt(13)
    v_mfma_f32_16x16x32_bf16 v[36:39], v[100:103], v[92:95], v[36:39]
    ds_read_b64 v[60:61], v24 offset:256
    ds_read_b64 v[62:63], v24 offset:264
    v_mfma_f32_16x16x32_bf16 v[40:43], v[104:107], v[92:95], v[40:43]
    v_mfma_f32_16x16x32_bf16 v[44:47], v[108:111], v[92:95], v[44:47]
    s_waitcnt lgkmcnt(10)
    v_mfma_f32_16x16x32_bf16 v[40:43], v[100:103], v[96:99], v[40:43]
    ds_read2_b32 v[132:133], v21 offset0:48 offset1:49
    ds_read2_b32 v[134:135], v21 offset0:50 offset1:51
    v_mfma_f32_16x16x32_bf16 v[44:47], v[104:107], v[96:99], v[44:47]
    ds_read_b64 v[84:85], v24 offset:1728
    ds_read_b64 v[86:87], v24 offset:1736
    v_mfma_f32_16x16x32_bf16 v[28:31], v[64:67], v[48:51], v[28:31]
    ds_read_b128 v[100:103], v14 offset:128
    s_waitcnt lgkmcnt(12)
    v_mfma_f32_16x16x32_bf16 v[32:35], v[68:71], v[48:51], v[32:35]
    ds_read_b128 v[104:107], v14 offset:640
    ds_read_b128 v[108:111], v14 offset:1152
    v_mfma_f32_16x16x32_bf16 v[36:39], v[72:75], v[48:51], v[36:39]
    ds_read_b128 v[112:115], v14 offset:1664
    v_mfma_f32_16x16x32_bf16 v[40:43], v[76:79], v[48:51], v[40:43]
    s_waitcnt lgkmcnt(12)
    v_mfma_f32_16x16x32_bf16 v[44:47], v[80:83], v[48:51], v[44:47]
    ds_read_b128 v[116:119], v14 offset:2176
    ds_read_b64 v[88:89], v24 offset:1216
    v_mfma_f32_16x16x32_bf16 v[32:35], v[64:67], v[52:55], v[32:35]
    ds_read_b64 v[90:91], v24 offset:1224
    v_mfma_f32_16x16x32_bf16 v[36:39], v[68:71], v[52:55], v[36:39]
    v_mfma_f32_16x16x32_bf16 v[40:43], v[72:75], v[52:55], v[40:43]
    v_mfma_f32_16x16x32_bf16 v[44:47], v[76:79], v[52:55], v[44:47]
    s_waitcnt lgkmcnt(13)
    v_mfma_f32_16x16x32_bf16 v[36:39], v[64:67], v[56:59], v[36:39]
    ds_read_b64 v[92:93], v24 offset:704
    ds_read_b64 v[94:95], v24 offset:712
    v_mfma_f32_16x16x32_bf16 v[40:43], v[68:71], v[56:59], v[40:43]
    v_mfma_f32_16x16x32_bf16 v[44:47], v[72:75], v[56:59], v[44:47]
    s_waitcnt lgkmcnt(11)
    v_mfma_f32_16x16x32_bf16 v[40:43], v[64:67], v[60:63], v[40:43]
    ds_read_b64 v[96:97], v24 offset:192
    ds_read_b64 v[98:99], v24 offset:200
    v_mfma_f32_16x16x32_bf16 v[44:47], v[68:71], v[60:63], v[44:47]
    v_mfma_f32_16x16x32_bf16 v[44:47], v[132:135], v[120:123], v[44:47]
    ds_read_b64 v[48:49], v24 offset:1664
    ds_read_b64 v[50:51], v24 offset:1672
    s_waitcnt lgkmcnt(10)
    v_mfma_f32_16x16x32_bf16 v[28:31], v[100:103], v[84:87], v[28:31]
    ds_read_b128 v[64:67], v14 offset:64
    ds_read_b128 v[68:71], v14 offset:576
    v_mfma_f32_16x16x32_bf16 v[32:35], v[104:107], v[84:87], v[32:35]
    ds_read_b128 v[72:75], v14 offset:1088
    ds_read_b128 v[76:79], v14 offset:1600
    v_mfma_f32_16x16x32_bf16 v[36:39], v[108:111], v[84:87], v[36:39]
    ds_read_b128 v[80:83], v14 offset:2112
    s_waitcnt lgkmcnt(11)
    v_mfma_f32_16x16x32_bf16 v[40:43], v[112:115], v[84:87], v[40:43]
    ds_read_b64 v[52:53], v24 offset:1152
    ds_read_b64 v[54:55], v24 offset:1160
    v_mfma_f32_16x16x32_bf16 v[44:47], v[116:119], v[84:87], v[44:47]
    ds_read_b64 v[56:57], v24 offset:640
    ds_read_b64 v[58:59], v24 offset:648
    v_mfma_f32_16x16x32_bf16 v[32:35], v[100:103], v[88:91], v[32:35]
    v_mfma_f32_16x16x32_bf16 v[36:39], v[104:107], v[88:91], v[36:39]
    v_mfma_f32_16x16x32_bf16 v[40:43], v[108:111], v[88:91], v[40:43]
    v_mfma_f32_16x16x32_bf16 v[44:47], v[112:115], v[88:91], v[44:47]
    s_waitcnt lgkmcnt(13)
    v_mfma_f32_16x16x32_bf16 v[36:39], v[100:103], v[92:95], v[36:39]
    ds_read_b64 v[60:61], v24 offset:128
    ds_read_b64 v[62:63], v24 offset:136
    v_mfma_f32_16x16x32_bf16 v[40:43], v[104:107], v[92:95], v[40:43]
    v_mfma_f32_16x16x32_bf16 v[44:47], v[108:111], v[92:95], v[44:47]
    s_waitcnt lgkmcnt(10)
    v_mfma_f32_16x16x32_bf16 v[40:43], v[100:103], v[96:99], v[40:43]
    v_mfma_f32_16x16x32_bf16 v[44:47], v[104:107], v[96:99], v[44:47]
    ds_read_b64 v[84:85], v24 offset:1600
    ds_read_b64 v[86:87], v24 offset:1608
    v_mfma_f32_16x16x32_bf16 v[28:31], v[64:67], v[48:51], v[28:31]
    ds_read_b128 v[100:103], v14 offset:0
    ds_read_b128 v[104:107], v14 offset:512
    s_waitcnt lgkmcnt(11)
    v_mfma_f32_16x16x32_bf16 v[32:35], v[68:71], v[48:51], v[32:35]
    ds_read_b128 v[108:111], v14 offset:1024
    ds_read_b128 v[112:115], v14 offset:1536
    v_mfma_f32_16x16x32_bf16 v[36:39], v[72:75], v[48:51], v[36:39]
    ds_read_b128 v[116:119], v14 offset:2048
    ds_read_b64 v[88:89], v24 offset:1088
    v_mfma_f32_16x16x32_bf16 v[40:43], v[76:79], v[48:51], v[40:43]
    s_waitcnt lgkmcnt(12)
    v_mfma_f32_16x16x32_bf16 v[44:47], v[80:83], v[48:51], v[44:47]
    ds_read_b64 v[90:91], v24 offset:1096
    ds_read_b64 v[92:93], v24 offset:576
    v_mfma_f32_16x16x32_bf16 v[32:35], v[64:67], v[52:55], v[32:35]
    ds_read_b64 v[94:95], v24 offset:584
    v_mfma_f32_16x16x32_bf16 v[36:39], v[68:71], v[52:55], v[36:39]
    v_mfma_f32_16x16x32_bf16 v[40:43], v[72:75], v[52:55], v[40:43]
    v_mfma_f32_16x16x32_bf16 v[44:47], v[76:79], v[52:55], v[44:47]
    s_waitcnt lgkmcnt(13)
    v_mfma_f32_16x16x32_bf16 v[36:39], v[64:67], v[56:59], v[36:39]
    ds_read_b64 v[96:97], v24 offset:64
    ds_read_b64 v[98:99], v24 offset:72
    v_mfma_f32_16x16x32_bf16 v[40:43], v[68:71], v[56:59], v[40:43]
    v_mfma_f32_16x16x32_bf16 v[44:47], v[72:75], v[56:59], v[44:47]
    s_waitcnt lgkmcnt(10)
    v_mfma_f32_16x16x32_bf16 v[40:43], v[64:67], v[60:63], v[40:43]
    v_mfma_f32_16x16x32_bf16 v[44:47], v[68:71], v[60:63], v[44:47]
    v_mfma_f32_16x16x32_bf16 v[28:31], v[100:103], v[84:87], v[28:31]
    s_waitcnt lgkmcnt(7)
    v_mfma_f32_16x16x32_bf16 v[32:35], v[104:107], v[84:87], v[32:35]
    v_mfma_f32_16x16x32_bf16 v[36:39], v[108:111], v[84:87], v[36:39]
    v_mfma_f32_16x16x32_bf16 v[40:43], v[112:115], v[84:87], v[40:43]
    s_waitcnt lgkmcnt(4)
    v_mfma_f32_16x16x32_bf16 v[44:47], v[116:119], v[84:87], v[44:47]
    v_mfma_f32_16x16x32_bf16 v[32:35], v[100:103], v[88:91], v[32:35]
    v_mfma_f32_16x16x32_bf16 v[36:39], v[104:107], v[88:91], v[36:39]
    v_mfma_f32_16x16x32_bf16 v[40:43], v[108:111], v[88:91], v[40:43]
    v_mfma_f32_16x16x32_bf16 v[44:47], v[112:115], v[88:91], v[44:47]
    s_waitcnt lgkmcnt(2)
    v_mfma_f32_16x16x32_bf16 v[36:39], v[100:103], v[92:95], v[36:39]
    v_mfma_f32_16x16x32_bf16 v[40:43], v[104:107], v[92:95], v[40:43]
    v_mfma_f32_16x16x32_bf16 v[44:47], v[108:111], v[92:95], v[44:47]
    s_waitcnt lgkmcnt(0)
    v_mfma_f32_16x16x32_bf16 v[40:43], v[100:103], v[96:99], v[40:43]
    v_mfma_f32_16x16x32_bf16 v[44:47], v[104:107], v[96:99], v[44:47]
    s_nop 5
    v_cvt_pk_bf16_f32 v48, v28, v29
    v_cvt_pk_bf16_f32 v49, v30, v31
    v_cvt_pk_bf16_f32 v50, v32, v33
    v_cvt_pk_bf16_f32 v51, v34, v35
    v_cvt_pk_bf16_f32 v52, v36, v37
    v_cvt_pk_bf16_f32 v53, v38, v39
    v_cvt_pk_bf16_f32 v54, v40, v41
    v_cvt_pk_bf16_f32 v55, v42, v43
    v_cvt_pk_bf16_f32 v56, v44, v45
    v_cvt_pk_bf16_f32 v57, v46, v47
    v_mov_b32 v60, v48
    v_mov_b32 v61, v49
    v_mov_b32 v62, v52
    v_mov_b32 v63, v53
    v_mov_b32 v64, v56
    v_mov_b32 v65, v57
    v_mov_b32_dpp v48, v50 row_ror:8 row_mask:0xf bank_mask:0xc
    v_mov_b32_dpp v49, v51 row_ror:8 row_mask:0xf bank_mask:0xc
    v_mov_b32_dpp v50, v60 row_ror:8 row_mask:0xf bank_mask:0x3
    v_mov_b32_dpp v51, v61 row_ror:8 row_mask:0xf bank_mask:0x3
    v_and_or_b32 v48, v48, s56, v15
    v_and_or_b32 v49, v49, s56, v15
    v_and_or_b32 v50, v50, s56, v15
    v_and_or_b32 v51, v51, s56, v15
    buffer_store_dwordx4 v[48:51], v6, s[72:75], s54 offen offset:0 sc1
    v_mov_b32_dpp v52, v54 row_ror:8 row_mask:0xf bank_mask:0xc
    v_mov_b32_dpp v53, v55 row_ror:8 row_mask:0xf bank_mask:0xc
    v_mov_b32_dpp v54, v62 row_ror:8 row_mask:0xf bank_mask:0x3
    v_mov_b32_dpp v55, v63 row_ror:8 row_mask:0xf bank_mask:0x3
    v_and_or_b32 v52, v52, s56, v15
    v_and_or_b32 v53, v53, s56, v15
    v_and_or_b32 v54, v54, s56, v15
    v_and_or_b32 v55, v55, s56, v15
    buffer_store_dwordx4 v[52:55], v6, s[72:75], s54 offen offset:1024 sc1
    v_mov_b32_dpp v58, v64 row_ror:8 row_mask:0xf bank_mask:0x3
    v_mov_b32_dpp v59, v65 row_ror:8 row_mask:0xf bank_mask:0x3
    v_and_or_b32 v56, v56, s56, v15
    v_and_or_b32 v57, v57, s56, v15
    v_and_or_b32 v58, v58, s56, v15
    v_and_or_b32 v59, v59, s56, v15
    s_mov_b32 exec_lo, 0x00ff00ff
    s_mov_b32 exec_hi, exec_lo
    buffer_store_dwordx4 v[56:59], v6, s[72:75], s54 offen offset:2048 sc1
    s_mov_b64 exec, -1
L_s_xj:
    s_mov_b64 exec, 1
    ds_add_u32 v9, v8 offset:0
    s_mov_b64 exec, -1
    s_setprio 2
    s_lshl_b32 s10, s55, 18
    s_lshl_b32 s11, s60, 16
    s_add_u32 s10, s10, s11
    s_lshl_b32 s11, s59, 7
    s_add_u32 s10, s10, s11
    s_add_u32 s10, s10, 0x800000
    s_add_u32 s11, s10, 4096
    s_add_u32 s12, s10, 8192
    s_add_u32 s13, s10, 12288
    v_lshlrev_b32 v3, 14, v2
    v_lshl_add_u32 v4, v1, 3, v3
    v_and_b32 v3, 1, v1
    v_lshrrev_b32 v1, 1, v1
    v_lshrrev_b32 v6, v1, s57
    v_and_b32 v6, 1, v6
    v_mul_u32_u24 v6, 0x4000, v6
    v_lshl_or_b32 v15, v6, 16, v6
    v_lshl_add_u32 v1, v3, 3, v1
    s_lshl_b32 s14, s59, 8
    s_add_u32 s14, s14, 0x1000
    v_lshlrev_b32 v5, 4, v1
    v_lshl_add_u32 v3, v2, 8, v5
    v_add_u32 v11, s58, v3
    v_add_u32 v12, 149632, v5
    v_and_b32 v3, 3, v0
    v_lshl_add_u32 v3, v3, 2, v9
    s_waitcnt lgkmcnt(0)
    s_branch L_s_gw_36
L_s_gw_35:
    s_sleep 4
L_s_gw_36:
    s_load_dwordx2 s[16:17], s[50:51], s101 glc
    s_add_u32 s66, s66, 0x1000
    s_cbranch_scc1 L_end
    s_waitcnt lgkmcnt(0)
    s_xor_b64 s[16:17], s[16:17], s[62:63]
    s_cbranch_scc1 L_s_gw_35
    buffer_load_dwordx4 v[48:51], v5, s[72:75], s14 offen sc1
    v_lshlrev_b32 v60, 16, v22
    v_and_b32 v61, 0xffff0000, v22
    v_lshlrev_b32 v62, 16, v23
    v_and_b32 v63, 0xffff0000, v23
    s_waitcnt vmcnt(0)
    v_sub_f32 v80, 1.0, v48
    v_mul_f32 v48, 0x5f800000, v48
    v_sub_f32 v81, 1.0, v49
    v_mul_f32 v49, 0x5f800000, v49
    v_sub_f32 v82, 1.0, v50
    v_mul_f32 v50, 0x5f800000, v50
    v_sub_f32 v83, 1.0, v51
    v_mul_f32 v51, 0x5f800000, v51
    v_mul_f32 v64, v80, v60
    v_mul_f32 v65, v80, v61
    v_mul_f32 v66, v80, v62
    v_mul_f32 v67, v80, v63
    v_mul_f32 v68, v81, v60
    v_mul_f32 v69, v81, v61
    v_mul_f32 v70, v81, v62
    v_mul_f32 v71, v81, v63
    v_mul_f32 v72, v82, v60
    v_mul_f32 v73, v82, v61
    v_mul_f32 v74, v82, v62
    v_mul_f32 v75, v82, v63
    v_mul_f32 v76, v83, v60
    v_mul_f32 v77, v83, v61
    v_mul_f32 v78, v83, v62
    v_mul_f32 v79, v83, v63
    s_branch L_s_aw_38
L_s_aw_37:
    s_sleep 4
L_s_aw_38:
    ds_read_b32 v10, v3 offset:32
    s_add_u32 s66, s66, 0x1000
    s_cbranch_scc1 L_end
    s_waitcnt lgkmcnt(0)
    v_cmp_gt_u32 vcc, 11, v10
    s_cbranch_vccnz L_s_aw_37
L_s_kd_39:
    ds_read_b32 v10, v9 offset:0
    s_add_u32 s66, s66, 0x1000
    s_cbranch_scc1 L_end
    s_waitcnt lgkmcnt(0)
    v_cmp_gt_u32 vcc, 8, v10
    s_cbranch_vccnz L_s_kd_39
L_s_aget:
    buffer_load_dwordx2 v[32:33], v4, s[72:75], s10 offen sc1
    buffer_load_dwordx2 v[34:35], v4, s[72:75], s11 offen sc1
    buffer_load_dwordx2 v[36:37], v4, s[72:75], s12 offen sc1
    buffer_load_dwordx2 v[38:39], v4, s[72:75], s13 offen sc1
    s_waitcnt vmcnt(0)
    v_xor_b32 v32, v32, v15
    v_xor_b32 v33, v33, v15
    v_xor_b32 v34, v34, v15
    v_xor_b32 v35, v35, v15
    v_xor_b32 v36, v36, v15
    v_xor_b32 v37, v37, v15
    v_xor_b32 v38, v38, v15
    v_xor_b32 v39, v39, v15
    v_or3_b32 v40, v32, v33, v34
    v_or3_b32 v41, v35, v36, v37
    v_or3_b32 v40, v40, v38, v39
    v_or_b32 v40, v40, v41
    v_and_b32 v40, 0x40004000, v40
    v_cmp_ne_u32 vcc, 0, v40
    s_cbranch_vccz L_s_aok
    s_add_u32 s66, s66, 0x1000
    s_cbranch_scc1 L_end
    s_sleep 5
    s_branch L_s_aget
L_s_aok:
    v_lshlrev_b32 v44, 16, v32
    v_lshlrev_b32 v45, 16, v34
    v_lshlrev_b32 v46, 16, v36
    v_lshlrev_b32 v47, 16, v38
    v_fmac_f32 v64, v48, v44
    v_fmac_f32 v65, v48, v45
    v_fmac_f32 v66, v48, v46
    v_fmac_f32 v67, v48, v47
    ds_write_b128 v11, v[64:67] offset:0
    v_and_b32 v44, 0xffff0000, v32
    v_and_b32 v45, 0xffff0000, v34
    v_and_b32 v46, 0xffff0000, v36
    v_and_b32 v47, 0xffff0000, v38
    v_fmac_f32 v68, v49, v44
    v_fmac_f32 v69, v49, v45
    v_fmac_f32 v70, v49, v46
    v_fmac_f32 v71, v49, v47
    ds_write_b128 v11, v[68:71] offset:1024
    v_lshlrev_b32 v44, 16, v33
    v_lshlrev_b32 v45, 16, v35
    v_lshlrev_b32 v46, 16, v37
    v_lshlrev_b32 v47, 16, v39
    v_fmac_f32 v72, v50, v44
    v_fmac_f32 v73, v50, v45
    v_fmac_f32 v74, v50, v46
    v_fmac_f32 v75, v50, v47
    ds_write_b128 v11, v[72:75] offset:2048
    v_and_b32 v44, 0xffff0000, v33
    v_and_b32 v45, 0xffff0000, v35
    v_and_b32 v46, 0xffff0000, v37
    v_and_b32 v47, 0xffff0000, v39
    v_fmac_f32 v76, v51, v44
    v_fmac_f32 v77, v51, v45
    v_fmac_f32 v78, v51, v46
    v_fmac_f32 v79, v51, v47
    ds_write_b128 v11, v[76:79] offset:3072
    s_mov_b64 exec, 0xffff
    ds_write_b128 v12, v[80:83]
    s_waitcnt lgkmcnt(0)
    s_endpgm
.p2align 8
L_cons:
    v_and_b32 v0, 63, v0
    s_mov_b32 s66, 0
    s_sub_u32 s60, s3, 4
    s_and_b32 s52, s60, 1
    s_lshr_b32 s53, s60, 1
    v_mov_b32 v9, 163712
    s_and_b32 s57, s2, 1
    s_lshl_b32 s57, s57, 3
    s_lshr_b32 s55, s2, 5
    s_add_u32 s57, s57, s55
    s_bfe_u32 s56, s2, 0x20001
    s_lshl_b32 s56, s56, 2
    s_bfe_u32 s54, s2, 0x20003
    s_add_u32 s56, s56, s54
    v_and_b32 v1, 15, v0
    v_lshrrev_b32 v130, 4, v0
    v_lshlrev_b32 v13, 1, v0
    s_waitcnt lgkmcnt(0)
    s_barrier
    s_mul_i32 s10, s57, 192
    s_mov_b32 s4, s38
    s_and_b32 s5, s39, 0xffff
    s_mov_b32 s6, 0xac0
    s_mov_b32 s7, 0x20000
    buffer_load_ushort v64, v13, s[4:7], s10 offen
    buffer_load_ushort v68, v13, s[4:7], s10 offen offset:128
    v_mov_b32 v65, 0
    v_mov_b32 v66, 0
    v_mov_b32 v67, 0
    v_mov_b32 v69, 0
    v_mov_b32 v70, 0
    v_mov_b32 v71, 0
    v_mov_b32 v73, 0
    v_mov_b32 v74, 0
    v_mov_b32 v75, 0
    v_mov_b32 v77, 0
    v_mov_b32 v78, 0
    v_mov_b32 v79, 0
    v_mov_b32 v81, 0
    v_mov_b32 v82, 0
    v_mov_b32 v83, 0
    v_mov_b32 v85, 0
    v_mov_b32 v86, 0
    v_mov_b32 v87, 0
    v_mov_b32 v3, 0x3f80
    v_cmp_eq_u32 vcc, 0, v130
    s_nop 1
    v_cndmask_b32 v72, 0, v3, vcc
    v_cmp_eq_u32 vcc, 1, v130
    s_nop 1
    v_cndmask_b32 v76, 0, v3, vcc
    v_cmp_eq_u32 vcc, 2, v130
    s_nop 1
    v_cndmask_b32 v80, 0, v3, vcc
    v_cmp_eq_u32 vcc, 3, v130
    s_nop 1
    v_cndmask_b32 v84, 0, v3, vcc
    v_bfe_u32 v3, v0, 1, 3
    v_xor_b32 v3, v3, v130
    v_lshlrev_b32 v3, 4, v3
    v_lshl_add_u32 v3, v1, 7, v3
    s_lshl_b32 s10, s60, 12
    v_add_u32 v134, s10, v3
    v_xor_b32 v135, 64, v134
    v_bfe_u32 v3, v0, 2, 2
    v_lshl_add_u32 v3, v130, 3, v3
    v_mul_u32_u24 v3, 192, v3
    v_bfe_u32 v8, v0, 4, 1
    v_lshl_add_u32 v3, v8, 5, v3
    v_and_b32 v8, 3, v0
    v_lshl_add_u32 v136, v8, 3, v3
    v_xor_b32 v137, 32, v136
    v_add_u32 v4, 45056, v134
    v_add_u32 v5, 45056, v135
    v_add_u32 v6, 32768, v136
    v_add_u32 v7, 32768, v137
    s_mov_b32 s96, 0x4001912
    s_mov_b32 s97, 0x19120b
    s_mov_b32 s98, 0x81d160f
    s_mov_b32 s99, s98
    v_and_b32 v11, 1, v0
    v_lshl_add_u32 v11, v11, 2, v9
    v_add_u32 v11, 16, v11
    s_getpc_b64 s[92:93]
L_tp_41:
    s_add_u32 s92, s92, L_tab-L_tp_41
    s_addc_u32 s93, s93, 0
    s_lshl_b32 s94, s60, 2
    s_add_u32 s94, s94, 163744
    s_mov_b32 m0, s94
    v_mov_b32 v14, 0
    s_mov_b32 s72, s50
    s_and_b32 s73, s51, 0xffff
    s_mov_b32 s74, 0xa00000
    s_mov_b32 s75, 0x20000
    v_lshlrev_b32 v13, 4, v0
    s_lshl_b32 s10, s56, 2
    s_add_u32 s58, s10, s60
    s_mul_i32 s10, s58, 86
    s_mul_i32 s11, s57, 6
    s_add_u32 s10, s10, s11
    s_lshl_b32 s10, s10, 10
    s_add_u32 s76, s10, 0x80000
    s_add_u32 s77, s76, 4096
    s_cmp_ge_u32 s57, 7
    s_cselect_b32 s10, 100, 0
    s_lshl_b32 s11, s57, 2
    s_add_u32 s10, s10, s11
    s_lshl_b32 s11, s58, 8
    s_add_u32 s10, s10, s11
    s_add_u32 s100, s10, 0x8000
    s_and_b32 s59, s2, 7
    s_lshl_b32 s59, s59, 2
    s_bfe_u32 s54, s2, 0x20003
    s_add_u32 s59, s59, s54
    s_lshr_b32 s55, s2, 5
    s_lshl_b32 s10, s59, 1
    s_add_u32 s10, s10, s52
    s_lshl_b32 s10, s10, 1
    s_add_u32 s10, s10, s53
    s_lshl_b32 s10, s10, 7
    s_add_u32 s101, s10, 0x8000
    s_load_dword s16, s[50:51], s101 glc
    s_setprio 3
    s_waitcnt vmcnt(0)
    v_mfma_f32_16x16x32_bf16 v[16:19], v[64:67], v[72:75], 0
    v_mfma_f32_16x16x32_bf16 v[20:23], v[64:67], v[72:75], 0
    v_mfma_f32_16x16x32_bf16 v[24:27], v[64:67], v[76:79], 0
    v_mfma_f32_16x16x32_bf16 v[28:31], v[64:67], v[76:79], 0
    v_mfma_f32_16x16x32_bf16 v[32:35], v[64:67], v[80:83], 0
    v_mfma_f32_16x16x32_bf16 v[36:39], v[64:67], v[80:83], 0
    v_mfma_f32_16x16x32_bf16 v[40:43], v[64:67], v[84:87], 0
    v_mfma_f32_16x16x32_bf16 v[44:47], v[64:67], v[84:87], 0
    v_mfma_f32_16x16x32_bf16 v[48:51], v[68:71], v[72:75], 0
    v_mfma_f32_16x16x32_bf16 v[52:55], v[68:71], v[72:75], 0
    v_mfma_f32_16x16x32_bf16 v[56:59], v[68:71], v[76:79], 0
    v_mfma_f32_16x16x32_bf16 v[60:63], v[68:71], v[76:79], 0
L_c_tag_42:
    ds_read_b64 v[2:3], v9 offset:8
    s_add_u32 s66, s66, 0x1000
    s_cbranch_scc1 L_end
    s_waitcnt lgkmcnt(0)
    v_readfirstlane_b32 s9, v3
    v_readfirstlane_b32 s62, v2
    s_cmp_eq_u32 s9, 0
    s_cbranch_scc1 L_c_tag_42
    s_mov_b32 s63, s62
    s_mov_b32 s12, 1
L_c_poll:
L_c_p0_43:
    ds_read_b32 v10, v11 offset:0
    s_add_u32 s66, s66, 0x1000
    s_cbranch_scc1 L_end
    s_waitcnt lgkmcnt(0)
    v_cmp_gt_u32 vcc, s12, v10
    s_cbranch_vccnz L_c_p0_43
L_c_rd:
    ds_read_b128 v[112:115], v4 offset:0
    ds_read_b128 v[116:119], v4 offset:2048
    ds_read_b64_tr_b16 v[64:65], v6 offset:0
    ds_read_b64_tr_b16 v[66:67], v6 offset:768
    ds_read_b64_tr_b16 v[68:69], v7 offset:0
    ds_read_b64_tr_b16 v[70:71], v7 offset:768
    ds_read_b64_tr_b16 v[72:73], v6 offset:64
    ds_read_b64_tr_b16 v[74:75], v6 offset:832
    ds_read_b64_tr_b16 v[76:77], v7 offset:64
    ds_read_b64_tr_b16 v[78:79], v7 offset:832
    ds_read_b64_tr_b16 v[80:81], v6 offset:128
    ds_read_b64_tr_b16 v[82:83], v6 offset:896
    ds_read_b64_tr_b16 v[84:85], v7 offset:128
    ds_read_b64_tr_b16 v[86:87], v7 offset:896
.p2align 3
L_c_loop:
    s_waitcnt lgkmcnt(6)
    v_mfma_f32_16x16x32_bf16 v[16:19], v[64:67], v[112:115], v[16:19]
    ds_read_b32 v10, v11
    ds_read_b128 v[120:123], v5 offset:0
    v_mfma_f32_16x16x32_bf16 v[20:23], v[64:67], v[116:119], v[20:23]
    ds_read_b128 v[124:127], v5 offset:2048
    ds_read_b64_tr_b16 v[88:89], v6 offset:6144
    v_mfma_f32_16x16x32_bf16 v[24:27], v[68:71], v[112:115], v[24:27]
    ds_read_b64_tr_b16 v[90:91], v6 offset:6912
    ds_read_b64_tr_b16 v[92:93], v7 offset:6144
    v_mfma_f32_16x16x32_bf16 v[28:31], v[68:71], v[116:119], v[28:31]
    ds_read_b64_tr_b16 v[94:95], v7 offset:6912
    ds_read_b64_tr_b16 v[96:97], v6 offset:6208
    v_mfma_f32_16x16x32_bf16 v[32:35], v[72:75], v[112:115], v[32:35]
    ds_read_b64_tr_b16 v[98:99], v6 offset:6976
    s_add_u32 s12, s12, 1
    v_mfma_f32_16x16x32_bf16 v[36:39], v[72:75], v[116:119], v[36:39]
    s_cmp_eq_u32 s12, 9
    s_cselect_b32 s12, -1, s12
    s_waitcnt lgkmcnt(8)
    v_mfma_f32_16x16x32_bf16 v[40:43], v[76:79], v[112:115], v[40:43]
    ds_read_b64_tr_b16 v[100:101], v7 offset:6208
    ds_read_b64_tr_b16 v[102:103], v7 offset:6976
    v_mfma_f32_16x16x32_bf16 v[44:47], v[76:79], v[116:119], v[44:47]
    ds_read_b64_tr_b16 v[104:105], v6 offset:6272
    ds_read_b64_tr_b16 v[106:107], v6 offset:7040
    v_mfma_f32_16x16x32_bf16 v[48:51], v[80:83], v[112:115], v[48:51]
    ds_read_b64_tr_b16 v[108:109], v7 offset:6272
    ds_read_b64_tr_b16 v[110:111], v7 offset:7040
    v_mfma_f32_16x16x32_bf16 v[52:55], v[80:83], v[116:119], v[52:55]
    s_and_b32 s13, s96, 0xff
    s_and_b32 s15, s98, 0xff
    v_cmp_gt_u32 vcc, s12, v10
    v_mfma_f32_16x16x32_bf16 v[56:59], v[84:87], v[112:115], v[56:59]
    s_lshl_b32 s13, s13, 12
    s_lshl_b32 s15, s15, 12
    v_add_u32 v4, s13, v134
    v_mfma_f32_16x16x32_bf16 v[60:63], v[84:87], v[116:119], v[60:63]
    v_add_u32 v6, s15, v136
    v_add_u32 v7, s15, v137
    s_cbranch_vccnz L_c_slow
    s_waitcnt lgkmcnt(6)
    v_mfma_f32_16x16x32_bf16 v[16:19], v[88:91], v[120:123], v[16:19]
    ds_read_b128 v[112:115], v4 offset:0
    ds_read_b128 v[116:119], v4 offset:2048
    v_mfma_f32_16x16x32_bf16 v[20:23], v[88:91], v[124:127], v[20:23]
    ds_read_b64_tr_b16 v[64:65], v6 offset:0
    ds_read_b64_tr_b16 v[66:67], v6 offset:768
    v_mfma_f32_16x16x32_bf16 v[24:27], v[92:95], v[120:123], v[24:27]
    ds_read_b64_tr_b16 v[68:69], v7 offset:0
    ds_read_b64_tr_b16 v[70:71], v7 offset:768
    v_mfma_f32_16x16x32_bf16 v[28:31], v[92:95], v[124:127], v[28:31]
    ds_read_b64_tr_b16 v[72:73], v6 offset:64
    ds_read_b64_tr_b16 v[74:75], v6 offset:832
    v_mfma_f32_16x16x32_bf16 v[32:35], v[96:99], v[120:123], v[32:35]
    v_add_u32 v5, s13, v135
    v_add_u32 v14, 4, v14
    v_mfma_f32_16x16x32_bf16 v[36:39], v[96:99], v[124:127], v[36:39]
    s_lshr_b64 s[96:97], s[96:97], 8
    s_lshr_b64 s[98:99], s[98:99], 8
    s_waitcnt lgkmcnt(8)
    v_mfma_f32_16x16x32_bf16 v[40:43], v[100:103], v[120:123], v[40:43]
    s_mov_b64 exec, 1
    global_load_lds_dword v14, s[92:93]
    s_mov_b64 exec, -1
    ds_read_b64_tr_b16 v[76:77], v7 offset:64
    v_mfma_f32_16x16x32_bf16 v[44:47], v[100:103], v[124:127], v[44:47]
    ds_read_b64_tr_b16 v[78:79], v7 offset:832
    v_mfma_f32_16x16x32_bf16 v[48:51], v[104:107], v[120:123], v[48:51]
    ds_read_b64_tr_b16 v[80:81], v6 offset:128
    v_mfma_f32_16x16x32_bf16 v[52:55], v[104:107], v[124:127], v[52:55]
    ds_read_b64_tr_b16 v[82:83], v6 offset:896
    v_mfma_f32_16x16x32_bf16 v[56:59], v[108:111], v[120:123], v[56:59]
    ds_read_b64_tr_b16 v[84:85], v7 offset:128
    v_mfma_f32_16x16x32_bf16 v[60:63], v[108:111], v[124:127], v[60:63]
    ds_read_b64_tr_b16 v[86:87], v7 offset:896
    s_branch L_c_loop
L_c_slow:
    s_waitcnt lgkmcnt(6)
    v_mfma_f32_16x16x32_bf16 v[16:19], v[88:91], v[120:123], v[16:19]
    v_add_u32 v5, s13, v135
    v_add_u32 v14, 4, v14
    v_mfma_f32_16x16x32_bf16 v[20:23], v[88:91], v[124:127], v[20:23]
    v_mfma_f32_16x16x32_bf16 v[24:27], v[92:95], v[120:123], v[24:27]
    v_mfma_f32_16x16x32_bf16 v[28:31], v[92:95], v[124:127], v[28:31]
    s_waitcnt lgkmcnt(0)
    s_mov_b64 exec, 1
    global_load_lds_dword v14, s[92:93]
    s_mov_b64 exec, -1
    ds_read_b32 v10, v11
    v_mfma_f32_16x16x32_bf16 v[32:35], v[96:99], v[120:123], v[32:35]
    v_mfma_f32_16x16x32_bf16 v[36:39], v[96:99], v[124:127], v[36:39]
    s_cmp_eq_u32 s12, -1
    s_cbranch_scc1 L_c_last
    s_lshr_b64 s[96:97], s[96:97], 8
    s_lshr_b64 s[98:99], s[98:99], 8
    v_mfma_f32_16x16x32_bf16 v[40:43], v[100:103], v[120:123], v[40:43]
    v_mfma_f32_16x16x32_bf16 v[44:47], v[100:103], v[124:127], v[44:47]
    v_mfma_f32_16x16x32_bf16 v[48:51], v[104:107], v[120:123], v[48:51]
    v_mfma_f32_16x16x32_bf16 v[52:55], v[104:107], v[124:127], v[52:55]
    s_waitcnt lgkmcnt(0)
    v_cmp_gt_u32 vcc, s12, v10
    v_mfma_f32_16x16x32_bf16 v[56:59], v[108:111], v[120:123], v[56:59]
    v_mfma_f32_16x16x32_bf16 v[60:63], v[108:111], v[124:127], v[60:63]
    s_cbranch_vccz L_c_rd
    s_branch L_c_poll
L_c_last:
    v_mfma_f32_16x16x32_bf16 v[40:43], v[100:103], v[120:123], v[40:43]
    v_mfma_f32_16x16x32_bf16 v[44:47], v[100:103], v[124:127], v[44:47]
    v_mfma_f32_16x16x32_bf16 v[48:51], v[104:107], v[120:123], v[48:51]
    v_mfma_f32_16x16x32_bf16 v[52:55], v[104:107], v[124:127], v[52:55]
    v_mfma_f32_16x16x32_bf16 v[56:59], v[108:111], v[120:123], v[56:59]
    v_mfma_f32_16x16x32_bf16 v[60:63], v[108:111], v[124:127], v[60:63]
    s_cmp_eq_u32 s57, 15
    s_cbranch_scc1 L_c_gate
    v_mul_f32 v16, v16, abs(v16)
    v_mul_f32 v17, v17, abs(v17)
    v_mul_f32 v18, v18, abs(v18)
    v_mul_f32 v19, v19, abs(v19)
    v_mul_f32 v24, v24, abs(v24)
    v_mul_f32 v25, v25, abs(v25)
    v_mul_f32 v26, v26, abs(v26)
    v_mul_f32 v27, v27, abs(v27)
    v_cvt_pk_bf16_f32 v64, v16, v17
    v_cvt_pk_bf16_f32 v65, v18, v19
    v_cvt_pk_bf16_f32 v66, v24, v25
    v_cvt_pk_bf16_f32 v67, v26, v27
    v_pk_max_i16 v64, v64, 0
    v_pk_max_i16 v65, v65, 0
    v_pk_max_i16 v66, v66, 0
    v_pk_max_i16 v67, v67, 0
    buffer_store_dwordx4 v[64:67], v13, s[72:75], s76 offen offset:0 sc1
    v_mul_f32 v20, v20, abs(v20)
    v_mul_f32 v21, v21, abs(v21)
    v_mul_f32 v22, v22, abs(v22)
    v_mul_f32 v23, v23, abs(v23)
    v_mul_f32 v28, v28, abs(v28)
    v_mul_f32 v29, v29, abs(v29)
    v_mul_f32 v30, v30, abs(v30)
    v_mul_f32 v31, v31, abs(v31)
    v_cvt_pk_bf16_f32 v68, v20, v21
    v_cvt_pk_bf16_f32 v69, v22, v23
    v_cvt_pk_bf16_f32 v70, v28, v29
    v_cvt_pk_bf16_f32 v71, v30, v31
    v_pk_max_i16 v68, v68, 0
    v_pk_max_i16 v69, v69, 0
    v_pk_max_i16 v70, v70, 0
    v_pk_max_i16 v71, v71, 0
    buffer_store_dwordx4 v[68:71], v13, s[72:75], s76 offen offset:1024 sc1
    s_cmp_eq_u32 s57, 14
    s_cbranch_scc1 L_c_e1done
    v_mul_f32 v32, v32, abs(v32)
    v_mul_f32 v33, v33, abs(v33)
    v_mul_f32 v34, v34, abs(v34)
    v_mul_f32 v35, v35, abs(v35)
    v_mul_f32 v40, v40, abs(v40)
    v_mul_f32 v41, v41, abs(v41)
    v_mul_f32 v42, v42, abs(v42)
    v_mul_f32 v43, v43, abs(v43)
    v_cvt_pk_bf16_f32 v72, v32, v33
    v_cvt_pk_bf16_f32 v73, v34, v35
    v_cvt_pk_bf16_f32 v74, v40, v41
    v_cvt_pk_bf16_f32 v75, v42, v43
    v_pk_max_i16 v72, v72, 0
    v_pk_max_i16 v73, v73, 0
    v_pk_max_i16 v74, v74, 0
    v_pk_max_i16 v75, v75, 0
    buffer_store_dwordx4 v[72:75], v13, s[72:75], s76 offen offset:2048 sc1
    v_mul_f32 v36, v36, abs(v36)
    v_mul_f32 v37, v37, abs(v37)
    v_mul_f32 v38, v38, abs(v38)
    v_mul_f32 v39, v39, abs(v39)
    v_mul_f32 v44, v44, abs(v44)
    v_mul_f32 v45, v45, abs(v45)
    v_mul_f32 v46, v46, abs(v46)
    v_mul_f32 v47, v47, abs(v47)
    v_cvt_pk_bf16_f32 v76, v36, v37
    v_cvt_pk_bf16_f32 v77, v38, v39
    v_cvt_pk_bf16_f32 v78, v44, v45
    v_cvt_pk_bf16_f32 v79, v46, v47
    v_pk_max_i16 v76, v76, 0
    v_pk_max_i16 v77, v77, 0
    v_pk_max_i16 v78, v78, 0
    v_pk_max_i16 v79, v79, 0
    buffer_store_dwordx4 v[76:79], v13, s[72:75], s76 offen offset:3072 sc1
    v_mul_f32 v48, v48, abs(v48)
    v_mul_f32 v49, v49, abs(v49)
    v_mul_f32 v50, v50, abs(v50)
    v_mul_f32 v51, v51, abs(v51)
    v_mul_f32 v56, v56, abs(v56)
    v_mul_f32 v57, v57, abs(v57)
    v_mul_f32 v58, v58, abs(v58)
    v_mul_f32 v59, v59, abs(v59)
    v_cvt_pk_bf16_f32 v80, v48, v49
    v_cvt_pk_bf16_f32 v81, v50, v51
    v_cvt_pk_bf16_f32 v82, v56, v57
    v_cvt_pk_bf16_f32 v83, v58, v59
    v_pk_max_i16 v80, v80, 0
    v_pk_max_i16 v81, v81, 0
    v_pk_max_i16 v82, v82, 0
    v_pk_max_i16 v83, v83, 0
    buffer_store_dwordx4 v[80:83], v13, s[72:75], s77 offen offset:0 sc1
    v_mul_f32 v52, v52, abs(v52)
    v_mul_f32 v53, v53, abs(v53)
    v_mul_f32 v54, v54, abs(v54)
    v_mul_f32 v55, v55, abs(v55)
    v_mul_f32 v60, v60, abs(v60)
    v_mul_f32 v61, v61, abs(v61)
    v_mul_f32 v62, v62, abs(v62)
    v_mul_f32 v63, v63, abs(v63)
    v_cvt_pk_bf16_f32 v84, v52, v53
    v_cvt_pk_bf16_f32 v85, v54, v55
    v_cvt_pk_bf16_f32 v86, v60, v61
    v_cvt_pk_bf16_f32 v87, v62, v63
    v_pk_max_i16 v84, v84, 0
    v_pk_max_i16 v85, v85, 0
    v_pk_max_i16 v86, v86, 0
    v_pk_max_i16 v87, v87, 0
    buffer_store_dwordx4 v[84:87], v13, s[72:75], s77 offen offset:1024 sc1
    s_branch L_c_e1done
L_c_gate:
    v_add_f32 v64, v16, v25
    v_mul_f32 v64, 0xbfb8aa3b, v64
    v_add_f32 v65, v20, v29
    v_mul_f32 v65, 0xbfb8aa3b, v65
    v_exp_f32 v64, v64
    v_exp_f32 v65, v65
    s_nop 0
    v_add_f32 v64, 1.0, v64
    v_add_f32 v65, 1.0, v65
    v_rcp_f32 v64, v64
    v_rcp_f32 v65, v65
    s_lshr_b32 s10, s58, 1
    s_and_b32 s11, s58, 1
    s_lshl_b32 s12, s10, 7
    s_lshl_b32 s13, s11, 2
    s_add_u32 s12, s12, s13
    s_add_u32 s100, s12, 0xc000
    s_lshl_b32 s10, s12, 1
    s_add_u32 s10, s10, 0x1000
    s_mov_b64 exec, 0xffff
    buffer_store_dwordx2 v[64:65], v13, s[72:75], s10 offen sc1
    s_mov_b64 exec, -1
L_c_e1done:
    s_waitcnt lgkmcnt(0)
    s_setprio 1
    v_lshrrev_b32 v2, 2, v0
    v_lshlrev_b32 v2, 7, v2
    v_bfe_u32 v3, v0, 3, 2
    s_lshl_b32 s10, s53, 1
    v_xor_b32 v3, s10, v3
    v_lshl_add_u32 v2, v3, 5, v2
    v_and_b32 v3, 3, v0
    v_lshl_add_u32 v2, v3, 3, v2
    v_mov_b32 v132, v2
    v_xor_b32 v133, 32, v2
    s_mul_i32 s10, s53, 12288
    v_add_u32 v4, s10, v2
    v_xor_b32 v5, 32, v4
    v_xor_b32 v6, 64, v4
    v_xor_b32 v7, 96, v4
    v_add_u32 v128, 53248, v4
    v_add_u32 v129, 53248, v5
    v_add_u32 v130, 53248, v6
    v_add_u32 v131, 53248, v7
    s_lshl_b32 s10, s59, 1
    s_add_u32 s10, s10, s52
    s_mul_i32 s10, s10, 86
    s_add_u32 s11, s10, 84
    s_lshl_b32 s11, s11, 10
    s_add_u32 s76, s11, 0x80000
    s_mul_i32 s11, s53, 42
    s_add_u32 s10, s10, s11
    s_lshl_b32 s10, s10, 10
    s_add_u32 s77, s10, 0x80000
    v_and_b32 v134, 3, v0
    v_lshl_add_u32 v134, v134, 2, v9
    v_mov_b32 v143, v11
    s_lshl_b32 s10, s53, 2
    s_add_u32 s10, s10, 163728
    v_mov_b32 v11, s10
    v_mov_b32 v8, s94
    v_mov_b32 v12, 8
    s_mov_b32 s10, 0
    s_mul_i32 s10, s10, 6144
    s_add_u32 s10, s10, s77
    s_add_u32 s11, s77, 43008
    s_mov_b32 s78, s10
    s_add_u32 s79, s10, 4096
    s_add_u32 s10, s10, 6144
    s_cmp_eq_u32 s10, s11
    s_cselect_b32 s10, s77, s10
    s_mov_b32 s80, s10
    s_add_u32 s81, s10, 4096
    s_add_u32 s10, s10, 6144
    s_cmp_eq_u32 s10, s11
    s_cselect_b32 s10, s77, s10
    s_mov_b32 s82, s10
    s_add_u32 s83, s10, 4096
    s_add_u32 s10, s10, 6144
    s_cmp_eq_u32 s10, s11
    s_cselect_b32 s10, s77, s10
    s_mov_b32 s84, s10
    s_add_u32 s85, s10, 4096
    s_add_u32 s10, s10, 6144
    s_cmp_eq_u32 s10, s11
    s_cselect_b32 s10, s77, s10
    s_mov_b32 s86, s10
    s_add_u32 s87, s10, 4096
    s_add_u32 s10, s10, 6144
    s_cmp_eq_u32 s10, s11
    s_cselect_b32 s10, s77, s10
    s_mov_b32 s88, s10
    s_add_u32 s89, s10, 4096
    s_add_u32 s10, s10, 6144
    s_cmp_eq_u32 s10, s11
    s_cselect_b32 s10, s77, s10
    s_mov_b32 s90, s10
    s_add_u32 s91, s10, 4096
    s_lshl_b32 s10, s60, 12
    s_add_u32 s11, s10, 53248
    v_add_u32 v136, s11, v13
    s_xor_b32 s11, s10, 8192
    s_add_u32 s11, s11, 53248
    v_add_u32 v137, s11, v13
    s_lshl_b32 s11, s53, 13
    s_lshl_b32 s12, s52, 11
    s_add_u32 s11, s11, s12
    s_add_u32 s11, s11, 131072
    v_add_u32 v138, s11, v13
    s_lshl_b32 s11, s52, 3
    s_add_u32 s11, s11, 149632
    v_lshl_add_u32 v139, v1, 4, s11
    s_mul_i32 s10, s60, 2560
    s_add_u32 s10, s10, 69632
    v_mul_u32_u24 v2, 80, v1
    v_lshrrev_b32 v3, 4, v0
    v_lshl_add_u32 v2, v3, 3, v2
    v_add_u32 v140, s10, v2
    v_lshrrev_b32 v3, 2, v0
    v_mul_u32_u24 v2, 80, v3
    v_and_b32 v10, 3, v0
    v_lshl_add_u32 v2, v10, 4, v2
    v_add_u32 v141, s10, v2
    v_lshlrev_b32 v3, 10, v3
    v_lshl_add_u32 v142, v10, 4, v3
    s_mov_b32 s4, s46
    s_and_b32 s5, s47, 0xffff
    s_mov_b32 s6, 0x200000
    s_mov_b32 s7, 0x20000
    s_lshl_b32 s10, s59, 1
    s_add_u32 s10, s10, s52
    s_lshl_b32 s10, s10, 15
    s_lshl_b32 s11, s55, 7
    s_add_u32 s10, s10, s11
    s_lshl_b32 s11, s53, 6
    s_add_u32 s96, s10, s11
    s_add_u32 s97, s96, 16384
    s_waitcnt vmcnt(0)
    s_mov_b32 s9, s62
    s_atomic_swap s9, s[50:51], s100
    s_cmp_lg_u32 s57, 14
    s_cbranch_scc1 L_g2_f1
    s_sub_u32 s100, s100, 128
    s_mov_b32 s8, s62
    s_atomic_swap s8, s[50:51], s100
L_g2_f1:
    s_waitcnt lgkmcnt(0)
L_g2_w_45:
    s_load_dwordx8 s[16:23], s[50:51], s101 glc
    s_add_u32 s66, s66, 0x1000
    s_cbranch_scc1 L_end
    s_waitcnt lgkmcnt(0)
    s_xor_b64 s[16:17], s[16:17], s[62:63]
    s_xor_b64 s[18:19], s[18:19], s[62:63]
    s_xor_b64 s[20:21], s[20:21], s[62:63]
    s_xor_b64 s[22:23], s[22:23], s[62:63]
    s_or_b64 s[16:17], s[16:17], s[18:19]
    s_or_b64 s[16:17], s[16:17], s[20:21]
    s_or_b64 s[16:17], s[16:17], s[22:23]
    s_cbranch_scc1 L_g2_w_45
    buffer_load_dwordx4 v[48:51], v13, s[72:75], s78 offen offset:0 sc1
    buffer_load_dwordx4 v[52:55], v13, s[72:75], s78 offen offset:1024 sc1
    buffer_load_dwordx4 v[56:59], v13, s[72:75], s78 offen offset:2048 sc1
    buffer_load_dwordx4 v[60:63], v13, s[72:75], s78 offen offset:3072 sc1
L_g2_p0_46:
    ds_read_b32 v10, v143 offset:0
    s_add_u32 s66, s66, 0x1000
    s_cbranch_scc1 L_end
    s_waitcnt lgkmcnt(0)
    v_cmp_gt_u32 vcc, 9, v10
    s_cbranch_vccnz L_g2_p0_46
    ds_read_b64_tr_b16 v[96:97], v6 offset:4096
    ds_read_b64_tr_b16 v[98:99], v6 offset:6144
    ds_read_b64_tr_b16 v[100:101], v7 offset:4096
    ds_read_b64_tr_b16 v[102:103], v7 offset:6144
    ds_read_b64_tr_b16 v[104:105], v4 offset:4096
    ds_read_b64_tr_b16 v[106:107], v4 offset:6144
    ds_read_b64_tr_b16 v[108:109], v5 offset:4096
    ds_read_b64_tr_b16 v[110:111], v5 offset:6144
    ds_read_b64_tr_b16 v[112:113], v6 offset:8192
    ds_read_b64_tr_b16 v[114:115], v6 offset:10240
    ds_read_b64_tr_b16 v[116:117], v7 offset:8192
    ds_read_b64_tr_b16 v[118:119], v7 offset:10240
    buffer_load_dwordx4 v[64:67], v13, s[72:75], s79 offen offset:0 sc1
    buffer_load_dwordx4 v[68:71], v13, s[72:75], s79 offen offset:1024 sc1
    buffer_load_dwordx4 v[72:75], v13, s[72:75], s80 offen offset:0 sc1
    buffer_load_dwordx4 v[76:79], v13, s[72:75], s80 offen offset:1024 sc1
    buffer_load_dwordx4 v[80:83], v13, s[72:75], s80 offen offset:2048 sc1
    buffer_load_dwordx4 v[84:87], v13, s[72:75], s80 offen offset:3072 sc1
    s_waitcnt vmcnt(8)
    s_waitcnt lgkmcnt(8)
    v_mfma_f32_16x16x32_bf16 v[32:35], v[96:99], v[48:51], 0
    ds_read_b32 v10, v11
    v_mfma_f32_16x16x32_bf16 v[36:39], v[96:99], v[52:55], 0
    ds_read_b64_tr_b16 v[120:121], v4 offset:8192
    ds_read_b64_tr_b16 v[122:123], v4 offset:10240
    v_mfma_f32_16x16x32_bf16 v[40:43], v[100:103], v[48:51], 0
    ds_read_b64_tr_b16 v[124:125], v5 offset:8192
    ds_read_b64_tr_b16 v[126:127], v5 offset:10240
    v_mfma_f32_16x16x32_bf16 v[44:47], v[100:103], v[52:55], 0
    buffer_load_dwordx4 v[88:91], v13, s[72:75], s81 offen offset:0 sc1
    buffer_load_dwordx4 v[92:95], v13, s[72:75], s81 offen offset:1024 sc1
    s_waitcnt lgkmcnt(9)
    v_mfma_f32_16x16x32_bf16 v[16:19], v[104:107], v[48:51], 0
    v_mfma_f32_16x16x32_bf16 v[20:23], v[104:107], v[52:55], 0
    ds_read_b64_tr_b16 v[96:97], v6 offset:12288
    ds_read_b64_tr_b16 v[98:99], v6 offset:14336
    v_mfma_f32_16x16x32_bf16 v[24:27], v[108:111], v[48:51], 0
    ds_read_b64_tr_b16 v[100:101], v7 offset:12288
    ds_read_b64_tr_b16 v[102:103], v7 offset:14336
    v_mfma_f32_16x16x32_bf16 v[28:31], v[108:111], v[52:55], 0
    s_waitcnt vmcnt(8)
    s_waitcnt lgkmcnt(9)
    v_mfma_f32_16x16x32_bf16 v[32:35], v[112:115], v[56:59], v[32:35]
    s_waitcnt lgkmcnt(8)
    v_cmp_gt_u32 vcc, 10, v10
    v_mfma_f32_16x16x32_bf16 v[36:39], v[112:115], v[60:63], v[36:39]
    ds_read_b64_tr_b16 v[104:105], v4 offset:12288
    ds_read_b64_tr_b16 v[106:107], v4 offset:14336
    v_mfma_f32_16x16x32_bf16 v[40:43], v[116:119], v[56:59], v[40:43]
    ds_read_b64_tr_b16 v[108:109], v5 offset:12288
    ds_read_b64_tr_b16 v[110:111], v5 offset:14336
    v_mfma_f32_16x16x32_bf16 v[44:47], v[116:119], v[60:63], v[44:47]
    buffer_load_dwordx4 v[48:51], v13, s[72:75], s82 offen offset:0 sc1
    s_waitcnt lgkmcnt(8)
    v_mfma_f32_16x16x32_bf16 v[16:19], v[120:123], v[56:59], v[16:19]
    s_cbranch_vccnz L_g2_pp_48
L_g2_pr_49:
    v_mfma_f32_16x16x32_bf16 v[20:23], v[120:123], v[60:63], v[20:23]
    ds_read_b64_tr_b16 v[112:113], v6 offset:28672
    ds_read_b64_tr_b16 v[114:115], v6 offset:30720
    v_mfma_f32_16x16x32_bf16 v[24:27], v[124:127], v[56:59], v[24:27]
    ds_read_b64_tr_b16 v[116:117], v7 offset:28672
    ds_read_b64_tr_b16 v[118:119], v7 offset:30720
    v_mfma_f32_16x16x32_bf16 v[28:31], v[124:127], v[60:63], v[28:31]
    buffer_load_dwordx4 v[52:55], v13, s[72:75], s82 offen offset:1024 sc1
    s_waitcnt vmcnt(8)
    s_waitcnt lgkmcnt(8)
    v_mfma_f32_16x16x32_bf16 v[32:35], v[96:99], v[64:67], v[32:35]
    v_mfma_f32_16x16x32_bf16 v[36:39], v[96:99], v[68:71], v[36:39]
    ds_read_b64_tr_b16 v[120:121], v4 offset:28672
    ds_read_b64_tr_b16 v[122:123], v4 offset:30720
    v_mfma_f32_16x16x32_bf16 v[40:43], v[100:103], v[64:67], v[40:43]
    ds_read_b64_tr_b16 v[124:125], v5 offset:28672
    ds_read_b64_tr_b16 v[126:127], v5 offset:30720
    v_mfma_f32_16x16x32_bf16 v[44:47], v[100:103], v[68:71], v[44:47]
    buffer_load_dwordx4 v[56:59], v13, s[72:75], s82 offen offset:2048 sc1
    s_waitcnt lgkmcnt(8)
    v_mfma_f32_16x16x32_bf16 v[16:19], v[104:107], v[64:67], v[16:19]
    v_add_u32 v12, 1, v12
    s_mov_b64 exec, 1
    ds_write_b32 v8, v12
    s_mov_b64 exec, -1
    v_mfma_f32_16x16x32_bf16 v[20:23], v[104:107], v[68:71], v[20:23]
    ds_read_b64_tr_b16 v[96:97], v6 offset:32768
    ds_read_b64_tr_b16 v[98:99], v6 offset:34816
    v_mfma_f32_16x16x32_bf16 v[24:27], v[108:111], v[64:67], v[24:27]
    ds_read_b64_tr_b16 v[100:101], v7 offset:32768
    ds_read_b64_tr_b16 v[102:103], v7 offset:34816
    v_mfma_f32_16x16x32_bf16 v[28:31], v[108:111], v[68:71], v[28:31]
    buffer_load_dwordx4 v[60:63], v13, s[72:75], s82 offen offset:3072 sc1
    s_waitcnt vmcnt(8)
    s_waitcnt lgkmcnt(9)
    v_mfma_f32_16x16x32_bf16 v[32:35], v[112:115], v[72:75], v[32:35]
    ds_read_b32 v10, v11
    v_mfma_f32_16x16x32_bf16 v[36:39], v[112:115], v[76:79], v[36:39]
    ds_read_b64_tr_b16 v[104:105], v4 offset:32768
    ds_read_b64_tr_b16 v[106:107], v4 offset:34816
    v_mfma_f32_16x16x32_bf16 v[40:43], v[116:119], v[72:75], v[40:43]
    ds_read_b64_tr_b16 v[108:109], v5 offset:32768
    ds_read_b64_tr_b16 v[110:111], v5 offset:34816
    v_mfma_f32_16x16x32_bf16 v[44:47], v[116:119], v[76:79], v[44:47]
    buffer_load_dwordx4 v[64:67], v13, s[72:75], s83 offen offset:0 sc1
    s_waitcnt lgkmcnt(10)
    v_mfma_f32_16x16x32_bf16 v[16:19], v[120:123], v[72:75], v[16:19]
    v_mfma_f32_16x16x32_bf16 v[20:23], v[120:123], v[76:79], v[20:23]
    ds_read_b64_tr_b16 v[112:113], v6 offset:36864
    ds_read_b64_tr_b16 v[114:115], v6 offset:38912
    v_mfma_f32_16x16x32_bf16 v[24:27], v[124:127], v[72:75], v[24:27]
    ds_read_b64_tr_b16 v[116:117], v7 offset:36864
    ds_read_b64_tr_b16 v[118:119], v7 offset:38912
    v_mfma_f32_16x16x32_bf16 v[28:31], v[124:127], v[76:79], v[28:31]
    buffer_load_dwordx4 v[68:71], v13, s[72:75], s83 offen offset:1024 sc1
    s_waitcnt vmcnt(8)
    s_waitcnt lgkmcnt(9)
    v_mfma_f32_16x16x32_bf16 v[32:35], v[96:99], v[80:83], v[32:35]
    s_waitcnt lgkmcnt(8)
    v_cmp_gt_u32 vcc, 11, v10
    v_mfma_f32_16x16x32_bf16 v[36:39], v[96:99], v[84:87], v[36:39]
    ds_read_b64_tr_b16 v[120:121], v4 offset:36864
    ds_read_b64_tr_b16 v[122:123], v4 offset:38912
    v_mfma_f32_16x16x32_bf16 v[40:43], v[100:103], v[80:83], v[40:43]
    ds_read_b64_tr_b16 v[124:125], v5 offset:36864
    ds_read_b64_tr_b16 v[126:127], v5 offset:38912
    v_mfma_f32_16x16x32_bf16 v[44:47], v[100:103], v[84:87], v[44:47]
    buffer_load_dwordx4 v[72:75], v13, s[72:75], s84 offen offset:0 sc1
    s_waitcnt lgkmcnt(8)
    v_mfma_f32_16x16x32_bf16 v[16:19], v[104:107], v[80:83], v[16:19]
    s_cbranch_vccnz L_g2_pp_50
L_g2_pr_51:
    v_mfma_f32_16x16x32_bf16 v[20:23], v[104:107], v[84:87], v[20:23]
    ds_read_b64_tr_b16 v[96:97], v130 offset:0
    ds_read_b64_tr_b16 v[98:99], v130 offset:2048
    v_mfma_f32_16x16x32_bf16 v[24:27], v[108:111], v[80:83], v[24:27]
    ds_read_b64_tr_b16 v[100:101], v131 offset:0
    ds_read_b64_tr_b16 v[102:103], v131 offset:2048
    v_mfma_f32_16x16x32_bf16 v[28:31], v[108:111], v[84:87], v[28:31]
    buffer_load_dwordx4 v[76:79], v13, s[72:75], s84 offen offset:1024 sc1
    s_waitcnt vmcnt(8)
    s_waitcnt lgkmcnt(8)
    v_mfma_f32_16x16x32_bf16 v[32:35], v[112:115], v[88:91], v[32:35]
    v_mfma_f32_16x16x32_bf16 v[36:39], v[112:115], v[92:95], v[36:39]
    ds_read_b64_tr_b16 v[104:105], v128 offset:0
    ds_read_b64_tr_b16 v[106:107], v128 offset:2048
    v_mfma_f32_16x16x32_bf16 v[40:43], v[116:119], v[88:91], v[40:43]
    ds_read_b64_tr_b16 v[108:109], v129 offset:0
    ds_read_b64_tr_b16 v[110:111], v129 offset:2048
    v_mfma_f32_16x16x32_bf16 v[44:47], v[116:119], v[92:95], v[44:47]
    buffer_load_dwordx4 v[80:83], v13, s[72:75], s84 offen offset:2048 sc1
    s_waitcnt lgkmcnt(8)
    v_mfma_f32_16x16x32_bf16 v[16:19], v[120:123], v[88:91], v[16:19]
    v_add_u32 v12, 1, v12
    s_mov_b64 exec, 1
    ds_write_b32 v8, v12
    s_mov_b64 exec, -1
    v_mfma_f32_16x16x32_bf16 v[20:23], v[120:123], v[92:95], v[20:23]
    ds_read_b64_tr_b16 v[112:113], v130 offset:4096
    ds_read_b64_tr_b16 v[114:115], v130 offset:6144
    v_mfma_f32_16x16x32_bf16 v[24:27], v[124:127], v[88:91], v[24:27]
    ds_read_b64_tr_b16 v[116:117], v131 offset:4096
    ds_read_b64_tr_b16 v[118:119], v131 offset:6144
    v_mfma_f32_16x16x32_bf16 v[28:31], v[124:127], v[92:95], v[28:31]
    buffer_load_dwordx4 v[84:87], v13, s[72:75], s84 offen offset:3072 sc1
    s_waitcnt vmcnt(8)
    s_waitcnt lgkmcnt(9)
    v_mfma_f32_16x16x32_bf16 v[32:35], v[96:99], v[48:51], v[32:35]
    ds_read_b32 v10, v11
    v_mfma_f32_16x16x32_bf16 v[36:39], v[96:99], v[52:55], v[36:39]
    ds_read_b64_tr_b16 v[120:121], v128 offset:4096
    ds_read_b64_tr_b16 v[122:123], v128 offset:6144
    v_mfma_f32_16x16x32_bf16 v[40:43], v[100:103], v[48:51], v[40:43]
    ds_read_b64_tr_b16 v[124:125], v129 offset:4096
    ds_read_b64_tr_b16 v[126:127], v129 offset:6144
    v_mfma_f32_16x16x32_bf16 v[44:47], v[100:103], v[52:55], v[44:47]
    buffer_load_dwordx4 v[88:91], v13, s[72:75], s85 offen offset:0 sc1
    s_waitcnt lgkmcnt(10)
    v_mfma_f32_16x16x32_bf16 v[16:19], v[104:107], v[48:51], v[16:19]
    v_mfma_f32_16x16x32_bf16 v[20:23], v[104:107], v[52:55], v[20:23]
    ds_read_b64_tr_b16 v[96:97], v130 offset:8192
    ds_read_b64_tr_b16 v[98:99], v130 offset:10240
    v_mfma_f32_16x16x32_bf16 v[24:27], v[108:111], v[48:51], v[24:27]
    ds_read_b64_tr_b16 v[100:101], v131 offset:8192
    ds_read_b64_tr_b16 v[102:103], v131 offset:10240
    v_mfma_f32_16x16x32_bf16 v[28:31], v[108:111], v[52:55], v[28:31]
    buffer_load_dwordx4 v[92:95], v13, s[72:75], s85 offen offset:1024 sc1
    s_waitcnt vmcnt(8)
    s_waitcnt lgkmcnt(9)
    v_mfma_f32_16x16x32_bf16 v[32:35], v[112:115], v[56:59], v[32:35]
    s_waitcnt lgkmcnt(8)
    v_cmp_gt_u32 vcc, 12, v10
    v_mfma_f32_16x16x32_bf16 v[36:39], v[112:115], v[60:63], v[36:39]
    ds_read_b64_tr_b16 v[104:105], v128 offset:8192
    ds_read_b64_tr_b16 v[106:107], v128 offset:10240
    v_mfma_f32_16x16x32_bf16 v[40:43], v[116:119], v[56:59], v[40:43]
    ds_read_b64_tr_b16 v[108:109], v129 offset:8192
    ds_read_b64_tr_b16 v[110:111], v129 offset:10240
    v_mfma_f32_16x16x32_bf16 v[44:47], v[116:119], v[60:63], v[44:47]
    buffer_load_dwordx4 v[48:51], v13, s[72:75], s86 offen offset:0 sc1
    s_waitcnt lgkmcnt(8)
    v_mfma_f32_16x16x32_bf16 v[16:19], v[120:123], v[56:59], v[16:19]
    s_cbranch_vccnz L_g2_pp_52
L_g2_pr_53:
    v_mfma_f32_16x16x32_bf16 v[20:23], v[120:123], v[60:63], v[20:23]
    ds_read_b64_tr_b16 v[112:113], v130 offset:24576
    ds_read_b64_tr_b16 v[114:115], v130 offset:26624
    v_mfma_f32_16x16x32_bf16 v[24:27], v[124:127], v[56:59], v[24:27]
    ds_read_b64_tr_b16 v[116:117], v131 offset:24576
    ds_read_b64_tr_b16 v[118:119], v131 offset:26624
    v_mfma_f32_16x16x32_bf16 v[28:31], v[124:127], v[60:63], v[28:31]
    buffer_load_dwordx4 v[52:55], v13, s[72:75], s86 offen offset:1024 sc1
    s_waitcnt vmcnt(8)
    s_waitcnt lgkmcnt(8)
    v_mfma_f32_16x16x32_bf16 v[32:35], v[96:99], v[64:67], v[32:35]
    v_mfma_f32_16x16x32_bf16 v[36:39], v[96:99], v[68:71], v[36:39]
    ds_read_b64_tr_b16 v[120:121], v128 offset:24576
    ds_read_b64_tr_b16 v[122:123], v128 offset:26624
    v_mfma_f32_16x16x32_bf16 v[40:43], v[100:103], v[64:67], v[40:43]
    ds_read_b64_tr_b16 v[124:125], v129 offset:24576
    ds_read_b64_tr_b16 v[126:127], v129 offset:26624
    v_mfma_f32_16x16x32_bf16 v[44:47], v[100:103], v[68:71], v[44:47]
    buffer_load_dwordx4 v[56:59], v13, s[72:75], s86 offen offset:2048 sc1
    s_waitcnt lgkmcnt(8)
    v_mfma_f32_16x16x32_bf16 v[16:19], v[104:107], v[64:67], v[16:19]
    v_add_u32 v12, 1, v12
    s_mov_b64 exec, 1
    ds_write_b32 v8, v12
    s_mov_b64 exec, -1
    v_mfma_f32_16x16x32_bf16 v[20:23], v[104:107], v[68:71], v[20:23]
    ds_read_b64_tr_b16 v[96:97], v130 offset:28672
    ds_read_b64_tr_b16 v[98:99], v130 offset:30720
    v_mfma_f32_16x16x32_bf16 v[24:27], v[108:111], v[64:67], v[24:27]
    ds_read_b64_tr_b16 v[100:101], v131 offset:28672
    ds_read_b64_tr_b16 v[102:103], v131 offset:30720
    v_mfma_f32_16x16x32_bf16 v[28:31], v[108:111], v[68:71], v[28:31]
    buffer_load_dwordx4 v[60:63], v13, s[72:75], s86 offen offset:3072 sc1
    s_waitcnt vmcnt(8)
    s_waitcnt lgkmcnt(9)
    v_mfma_f32_16x16x32_bf16 v[32:35], v[112:115], v[72:75], v[32:35]
    ds_read_b32 v10, v11
    v_mfma_f32_16x16x32_bf16 v[36:39], v[112:115], v[76:79], v[36:39]
    ds_read_b64_tr_b16 v[104:105], v128 offset:28672
    ds_read_b64_tr_b16 v[106:107], v128 offset:30720
    v_mfma_f32_16x16x32_bf16 v[40:43], v[116:119], v[72:75], v[40:43]
    ds_read_b64_tr_b16 v[108:109], v129 offset:28672
    ds_read_b64_tr_b16 v[110:111], v129 offset:30720
    v_mfma_f32_16x16x32_bf16 v[44:47], v[116:119], v[76:79], v[44:47]
    buffer_load_dwordx4 v[64:67], v13, s[72:75], s87 offen offset:0 sc1
    s_waitcnt lgkmcnt(10)
    v_mfma_f32_16x16x32_bf16 v[16:19], v[120:123], v[72:75], v[16:19]
    v_mfma_f32_16x16x32_bf16 v[20:23], v[120:123], v[76:79], v[20:23]
    ds_read_b64_tr_b16 v[112:113], v130 offset:32768
    ds_read_b64_tr_b16 v[114:115], v130 offset:34816
    v_mfma_f32_16x16x32_bf16 v[24:27], v[124:127], v[72:75], v[24:27]
    ds_read_b64_tr_b16 v[116:117], v131 offset:32768
    ds_read_b64_tr_b16 v[118:119], v131 offset:34816
    v_mfma_f32_16x16x32_bf16 v[28:31], v[124:127], v[76:79], v[28:31]
    buffer_load_dwordx4 v[68:71], v13, s[72:75], s87 offen offset:1024 sc1
    s_waitcnt vmcnt(8)
    s_waitcnt lgkmcnt(9)
    v_mfma_f32_16x16x32_bf16 v[32:35], v[96:99], v[80:83], v[32:35]
    s_waitcnt lgkmcnt(8)
    v_cmp_gt_u32 vcc, 13, v10
    v_mfma_f32_16x16x32_bf16 v[36:39], v[96:99], v[84:87], v[36:39]
    ds_read_b64_tr_b16 v[120:121], v128 offset:32768
    ds_read_b64_tr_b16 v[122:123], v128 offset:34816
    v_mfma_f32_16x16x32_bf16 v[40:43], v[100:103], v[80:83], v[40:43]
    ds_read_b64_tr_b16 v[124:125], v129 offset:32768
    ds_read_b64_tr_b16 v[126:127], v129 offset:34816
    v_mfma_f32_16x16x32_bf16 v[44:47], v[100:103], v[84:87], v[44:47]
    buffer_load_dwordx4 v[72:75], v13, s[72:75], s88 offen offset:0 sc1
    s_waitcnt lgkmcnt(8)
    v_mfma_f32_16x16x32_bf16 v[16:19], v[104:107], v[80:83], v[16:19]
    s_cbranch_vccnz L_g2_pp_54
L_g2_pr_55:
    v_mfma_f32_16x16x32_bf16 v[20:23], v[104:107], v[84:87], v[20:23]
    ds_read_b64_tr_b16 v[96:97], v130 offset:49152
    ds_read_b64_tr_b16 v[98:99], v130 offset:51200
    v_mfma_f32_16x16x32_bf16 v[24:27], v[108:111], v[80:83], v[24:27]
    ds_read_b64_tr_b16 v[100:101], v131 offset:49152
    ds_read_b64_tr_b16 v[102:103], v131 offset:51200
    v_mfma_f32_16x16x32_bf16 v[28:31], v[108:111], v[84:87], v[28:31]
    buffer_load_dwordx4 v[76:79], v13, s[72:75], s88 offen offset:1024 sc1
    s_waitcnt vmcnt(8)
    s_waitcnt lgkmcnt(8)
    v_mfma_f32_16x16x32_bf16 v[32:35], v[112:115], v[88:91], v[32:35]
    v_mfma_f32_16x16x32_bf16 v[36:39], v[112:115], v[92:95], v[36:39]
    ds_read_b64_tr_b16 v[104:105], v128 offset:49152
    ds_read_b64_tr_b16 v[106:107], v128 offset:51200
    v_mfma_f32_16x16x32_bf16 v[40:43], v[116:119], v[88:91], v[40:43]
    ds_read_b64_tr_b16 v[108:109], v129 offset:49152
    ds_read_b64_tr_b16 v[110:111], v129 offset:51200
    v_mfma_f32_16x16x32_bf16 v[44:47], v[116:119], v[92:95], v[44:47]
    buffer_load_dwordx4 v[80:83], v13, s[72:75], s88 offen offset:2048 sc1
    s_waitcnt lgkmcnt(8)
    v_mfma_f32_16x16x32_bf16 v[16:19], v[120:123], v[88:91], v[16:19]
    v_add_u32 v12, 1, v12
    s_mov_b64 exec, 1
    ds_write_b32 v8, v12
    s_mov_b64 exec, -1
    v_mfma_f32_16x16x32_bf16 v[20:23], v[120:123], v[92:95], v[20:23]
    ds_read_b64_tr_b16 v[112:113], v130 offset:53248
    ds_read_b64_tr_b16 v[114:115], v130 offset:55296
    v_mfma_f32_16x16x32_bf16 v[24:27], v[124:127], v[88:91], v[24:27]
    ds_read_b64_tr_b16 v[116:117], v131 offset:53248
    ds_read_b64_tr_b16 v[118:119], v131 offset:55296
    v_mfma_f32_16x16x32_bf16 v[28:31], v[124:127], v[92:95], v[28:31]
    buffer_load_dwordx4 v[84:87], v13, s[72:75], s88 offen offset:3072 sc1
    s_waitcnt vmcnt(8)
    s_waitcnt lgkmcnt(9)
    v_mfma_f32_16x16x32_bf16 v[32:35], v[96:99], v[48:51], v[32:35]
    ds_read_b32 v10, v11
    v_mfma_f32_16x16x32_bf16 v[36:39], v[96:99], v[52:55], v[36:39]
    ds_read_b64_tr_b16 v[120:121], v128 offset:53248
    ds_read_b64_tr_b16 v[122:123], v128 offset:55296
    v_mfma_f32_16x16x32_bf16 v[40:43], v[100:103], v[48:51], v[40:43]
    ds_read_b64_tr_b16 v[124:125], v129 offset:53248
    ds_read_b64_tr_b16 v[126:127], v129 offset:55296
    v_mfma_f32_16x16x32_bf16 v[44:47], v[100:103], v[52:55], v[44:47]
    buffer_load_dwordx4 v[88:91], v13, s[72:75], s89 offen offset:0 sc1
    s_waitcnt lgkmcnt(10)
    v_mfma_f32_16x16x32_bf16 v[16:19], v[104:107], v[48:51], v[16:19]
    v_mfma_f32_16x16x32_bf16 v[20:23], v[104:107], v[52:55], v[20:23]
    ds_read_b64_tr_b16 v[96:97], v130 offset:57344
    ds_read_b64_tr_b16 v[98:99], v130 offset:59392
    v_mfma_f32_16x16x32_bf16 v[24:27], v[108:111], v[48:51], v[24:27]
    ds_read_b64_tr_b16 v[100:101], v131 offset:57344
    ds_read_b64_tr_b16 v[102:103], v131 offset:59392
    v_mfma_f32_16x16x32_bf16 v[28:31], v[108:111], v[52:55], v[28:31]
    buffer_load_dwordx4 v[92:95], v13, s[72:75], s89 offen offset:1024 sc1
    s_waitcnt vmcnt(8)
    s_waitcnt lgkmcnt(9)
    v_mfma_f32_16x16x32_bf16 v[32:35], v[112:115], v[56:59], v[32:35]
    s_waitcnt lgkmcnt(8)
    v_cmp_gt_u32 vcc, 14, v10
    v_mfma_f32_16x16x32_bf16 v[36:39], v[112:115], v[60:63], v[36:39]
    ds_read_b64_tr_b16 v[104:105], v128 offset:57344
    ds_read_b64_tr_b16 v[106:107], v128 offset:59392
    v_mfma_f32_16x16x32_bf16 v[40:43], v[116:119], v[56:59], v[40:43]
    ds_read_b64_tr_b16 v[108:109], v129 offset:57344
    ds_read_b64_tr_b16 v[110:111], v129 offset:59392
    v_mfma_f32_16x16x32_bf16 v[44:47], v[116:119], v[60:63], v[44:47]
    buffer_load_dwordx4 v[48:51], v13, s[72:75], s90 offen offset:0 sc1
    s_waitcnt lgkmcnt(8)
    v_mfma_f32_16x16x32_bf16 v[16:19], v[120:123], v[56:59], v[16:19]
    s_cbranch_vccnz L_g2_pp_56
L_g2_pr_57:
    v_mfma_f32_16x16x32_bf16 v[20:23], v[120:123], v[60:63], v[20:23]
    ds_read_b64_tr_b16 v[112:113], v6 offset:4096
    ds_read_b64_tr_b16 v[114:115], v6 offset:6144
    v_mfma_f32_16x16x32_bf16 v[24:27], v[124:127], v[56:59], v[24:27]
    ds_read_b64_tr_b16 v[116:117], v7 offset:4096
    ds_read_b64_tr_b16 v[118:119], v7 offset:6144
    v_mfma_f32_16x16x32_bf16 v[28:31], v[124:127], v[60:63], v[28:31]
    buffer_load_dwordx4 v[52:55], v13, s[72:75], s90 offen offset:1024 sc1
    s_waitcnt vmcnt(8)
    s_waitcnt lgkmcnt(8)
    v_mfma_f32_16x16x32_bf16 v[32:35], v[96:99], v[64:67], v[32:35]
    v_mfma_f32_16x16x32_bf16 v[36:39], v[96:99], v[68:71], v[36:39]
    ds_read_b64_tr_b16 v[120:121], v4 offset:4096
    ds_read_b64_tr_b16 v[122:123], v4 offset:6144
    v_mfma_f32_16x16x32_bf16 v[40:43], v[100:103], v[64:67], v[40:43]
    ds_read_b64_tr_b16 v[124:125], v5 offset:4096
    ds_read_b64_tr_b16 v[126:127], v5 offset:6144
    v_mfma_f32_16x16x32_bf16 v[44:47], v[100:103], v[68:71], v[44:47]
    buffer_load_dwordx4 v[56:59], v13, s[72:75], s90 offen offset:2048 sc1
    s_waitcnt lgkmcnt(8)
    v_mfma_f32_16x16x32_bf16 v[16:19], v[104:107], v[64:67], v[16:19]
    v_mfma_f32_16x16x32_bf16 v[20:23], v[104:107], v[68:71], v[20:23]
    ds_read_b64_tr_b16 v[96:97], v6 offset:8192
    ds_read_b64_tr_b16 v[98:99], v6 offset:10240
    v_mfma_f32_16x16x32_bf16 v[24:27], v[108:111], v[64:67], v[24:27]
    ds_read_b64_tr_b16 v[100:101], v7 offset:8192
    ds_read_b64_tr_b16 v[102:103], v7 offset:10240
    v_mfma_f32_16x16x32_bf16 v[28:31], v[108:111], v[68:71], v[28:31]
    buffer_load_dwordx4 v[60:63], v13, s[72:75], s90 offen offset:3072 sc1
    s_waitcnt vmcnt(8)
    s_waitcnt lgkmcnt(8)
    v_mfma_f32_16x16x32_bf16 v[32:35], v[112:115], v[72:75], v[32:35]
    ds_read_b32 v10, v11
    v_mfma_f32_16x16x32_bf16 v[36:39], v[112:115], v[76:79], v[36:39]
    ds_read_b64_tr_b16 v[104:105], v4 offset:8192
    ds_read_b64_tr_b16 v[106:107], v4 offset:10240
    v_mfma_f32_16x16x32_bf16 v[40:43], v[116:119], v[72:75], v[40:43]
    ds_read_b64_tr_b16 v[108:109], v5 offset:8192
    ds_read_b64_tr_b16 v[110:111], v5 offset:10240
    v_mfma_f32_16x16x32_bf16 v[44:47], v[116:119], v[76:79], v[44:47]
    buffer_load_dwordx4 v[64:67], v13, s[72:75], s91 offen offset:0 sc1
    s_waitcnt lgkmcnt(9)
    v_mfma_f32_16x16x32_bf16 v[16:19], v[120:123], v[72:75], v[16:19]
    v_mfma_f32_16x16x32_bf16 v[20:23], v[120:123], v[76:79], v[20:23]
    ds_read_b64_tr_b16 v[112:113], v6 offset:12288
    ds_read_b64_tr_b16 v[114:115], v6 offset:14336
    v_mfma_f32_16x16x32_bf16 v[24:27], v[124:127], v[72:75], v[24:27]
    ds_read_b64_tr_b16 v[116:117], v7 offset:12288
    ds_read_b64_tr_b16 v[118:119], v7 offset:14336
    v_mfma_f32_16x16x32_bf16 v[28:31], v[124:127], v[76:79], v[28:31]
    buffer_load_dwordx4 v[68:71], v13, s[72:75], s91 offen offset:1024 sc1
    s_waitcnt vmcnt(8)
    s_waitcnt lgkmcnt(9)
    v_mfma_f32_16x16x32_bf16 v[32:35], v[96:99], v[80:83], v[32:35]
    s_waitcnt lgkmcnt(8)
    v_cmp_gt_u32 vcc, 15, v10
    v_mfma_f32_16x16x32_bf16 v[36:39], v[96:99], v[84:87], v[36:39]
    ds_read_b64_tr_b16 v[120:121], v4 offset:12288
    ds_read_b64_tr_b16 v[122:123], v4 offset:14336
    v_mfma_f32_16x16x32_bf16 v[40:43], v[100:103], v[80:83], v[40:43]
    ds_read_b64_tr_b16 v[124:125], v5 offset:12288
    ds_read_b64_tr_b16 v[126:127], v5 offset:14336
    v_mfma_f32_16x16x32_bf16 v[44:47], v[100:103], v[84:87], v[44:47]
    buffer_load_dwordx4 v[72:75], v13, s[72:75], s76 offen offset:0 sc1
    s_waitcnt lgkmcnt(8)
    v_mfma_f32_16x16x32_bf16 v[16:19], v[104:107], v[80:83], v[16:19]
    s_cbranch_vccnz L_g2_pp_58
L_g2_pr_59:
    v_mfma_f32_16x16x32_bf16 v[20:23], v[104:107], v[84:87], v[20:23]
    ds_read_b64_tr_b16 v[96:97], v6 offset:28672
    ds_read_b64_tr_b16 v[98:99], v6 offset:30720
    v_mfma_f32_16x16x32_bf16 v[24:27], v[108:111], v[80:83], v[24:27]
    ds_read_b64_tr_b16 v[100:101], v7 offset:28672
    ds_read_b64_tr_b16 v[102:103], v7 offset:30720
    v_mfma_f32_16x16x32_bf16 v[28:31], v[108:111], v[84:87], v[28:31]
    buffer_load_dwordx4 v[76:79], v13, s[72:75], s76 offen offset:1024 sc1
    s_waitcnt vmcnt(8)
    s_waitcnt lgkmcnt(8)
    v_mfma_f32_16x16x32_bf16 v[32:35], v[112:115], v[88:91], v[32:35]
    v_mfma_f32_16x16x32_bf16 v[36:39], v[112:115], v[92:95], v[36:39]
    ds_read_b64_tr_b16 v[104:105], v4 offset:28672
    ds_read_b64_tr_b16 v[106:107], v4 offset:30720
    v_mfma_f32_16x16x32_bf16 v[40:43], v[116:119], v[88:91], v[40:43]
    ds_read_b64_tr_b16 v[108:109], v5 offset:28672
    ds_read_b64_tr_b16 v[110:111], v5 offset:30720
    v_mfma_f32_16x16x32_bf16 v[44:47], v[116:119], v[92:95], v[44:47]
    s_waitcnt lgkmcnt(8)
    v_mfma_f32_16x16x32_bf16 v[16:19], v[120:123], v[88:91], v[16:19]
    v_mfma_f32_16x16x32_bf16 v[20:23], v[120:123], v[92:95], v[20:23]
    ds_read_b64_tr_b16 v[112:113], v6 offset:32768
    ds_read_b64_tr_b16 v[114:115], v6 offset:34816
    v_mfma_f32_16x16x32_bf16 v[24:27], v[124:127], v[88:91], v[24:27]
    ds_read_b64_tr_b16 v[116:117], v7 offset:32768
    ds_read_b64_tr_b16 v[118:119], v7 offset:34816
    v_mfma_f32_16x16x32_bf16 v[28:31], v[124:127], v[92:95], v[28:31]
    s_waitcnt vmcnt(6)
    s_waitcnt lgkmcnt(8)
    v_mfma_f32_16x16x32_bf16 v[32:35], v[96:99], v[48:51], v[32:35]
    v_mfma_f32_16x16x32_bf16 v[36:39], v[96:99], v[52:55], v[36:39]
    ds_read_b64_tr_b16 v[120:121], v4 offset:32768
    ds_read_b64_tr_b16 v[122:123], v4 offset:34816
    v_mfma_f32_16x16x32_bf16 v[40:43], v[100:103], v[48:51], v[40:43]
    ds_read_b64_tr_b16 v[124:125], v5 offset:32768
    ds_read_b64_tr_b16 v[126:127], v5 offset:34816
    v_mfma_f32_16x16x32_bf16 v[44:47], v[100:103], v[52:55], v[44:47]
    s_waitcnt lgkmcnt(8)
    v_mfma_f32_16x16x32_bf16 v[16:19], v[104:107], v[48:51], v[16:19]
    v_mfma_f32_16x16x32_bf16 v[20:23], v[104:107], v[52:55], v[20:23]
    ds_read_b64_tr_b16 v[96:97], v6 offset:36864
    ds_read_b64_tr_b16 v[98:99], v6 offset:38912
    v_mfma_f32_16x16x32_bf16 v[24:27], v[108:111], v[48:51], v[24:27]
    ds_read_b64_tr_b16 v[100:101], v7 offset:36864
    ds_read_b64_tr_b16 v[102:103], v7 offset:38912
    v_mfma_f32_16x16x32_bf16 v[28:31], v[108:111], v[52:55], v[28:31]
    s_waitcnt vmcnt(4)
    s_waitcnt lgkmcnt(8)
    v_mfma_f32_16x16x32_bf16 v[32:35], v[112:115], v[56:59], v[32:35]
    ds_read_b32 v135, v134 offset:32
    v_mfma_f32_16x16x32_bf16 v[36:39], v[112:115], v[60:63], v[36:39]
    ds_read_b64_tr_b16 v[104:105], v4 offset:36864
    ds_read_b64_tr_b16 v[106:107], v4 offset:38912
    v_mfma_f32_16x16x32_bf16 v[40:43], v[116:119], v[56:59], v[40:43]
    ds_read_b64_tr_b16 v[108:109], v5 offset:36864
    ds_read_b64_tr_b16 v[110:111], v5 offset:38912
    v_mfma_f32_16x16x32_bf16 v[44:47], v[116:119], v[60:63], v[44:47]
    s_waitcnt lgkmcnt(9)
    v_mfma_f32_16x16x32_bf16 v[16:19], v[120:123], v[56:59], v[16:19]
    v_mfma_f32_16x16x32_bf16 v[20:23], v[120:123], v[60:63], v[20:23]
    ds_read_b64_tr_b16 v[112:113], v132 offset:0
    ds_read_b64_tr_b16 v[114:115], v132 offset:2048
    v_mfma_f32_16x16x32_bf16 v[24:27], v[124:127], v[56:59], v[24:27]
    ds_read_b64_tr_b16 v[116:117], v133 offset:0
    ds_read_b64_tr_b16 v[118:119], v133 offset:2048
    v_mfma_f32_16x16x32_bf16 v[28:31], v[124:127], v[60:63], v[28:31]
    s_waitcnt vmcnt(2)
    s_waitcnt lgkmcnt(9)
    v_mfma_f32_16x16x32_bf16 v[32:35], v[96:99], v[64:67], v[32:35]
    v_mfma_f32_16x16x32_bf16 v[36:39], v[96:99], v[68:71], v[36:39]
    v_mfma_f32_16x16x32_bf16 v[40:43], v[100:103], v[64:67], v[40:43]
    v_mfma_f32_16x16x32_bf16 v[44:47], v[100:103], v[68:71], v[44:47]
    s_waitcnt lgkmcnt(8)
    v_cmp_gt_u32 vcc, 12, v135
    s_waitcnt lgkmcnt(4)
    v_mfma_f32_16x16x32_bf16 v[16:19], v[104:107], v[64:67], v[16:19]
    v_mfma_f32_16x16x32_bf16 v[20:23], v[104:107], v[68:71], v[20:23]
    v_mfma_f32_16x16x32_bf16 v[24:27], v[108:111], v[64:67], v[24:27]
    v_mfma_f32_16x16x32_bf16 v[28:31], v[108:111], v[68:71], v[28:31]
    s_cbranch_vccz L_g2_red
L_g2_fw_60:
    ds_read_b32 v135, v134 offset:32
    s_add_u32 s66, s66, 0x1000
    s_cbranch_scc1 L_end
    s_waitcnt lgkmcnt(0)
    v_cmp_gt_u32 vcc, 12, v135
    s_cbranch_vccnz L_g2_fw_60
L_g2_red:
    s_nop 2
    ds_write_b128 v136, v[32:35] offset:0
    ds_write_b128 v136, v[36:39] offset:1024
    ds_write_b128 v136, v[40:43] offset:2048
    ds_write_b128 v136, v[44:47] offset:3072
    s_waitcnt vmcnt(0)
    s_waitcnt lgkmcnt(4)
    v_mfma_f32_16x16x32_bf16 v[16:19], v[112:115], v[72:75], v[16:19]
    v_mfma_f32_16x16x32_bf16 v[20:23], v[112:115], v[76:79], v[20:23]
    v_mfma_f32_16x16x32_bf16 v[24:27], v[116:119], v[72:75], v[24:27]
    v_mfma_f32_16x16x32_bf16 v[28:31], v[116:119], v[76:79], v[28:31]
    s_waitcnt lgkmcnt(0)
    s_barrier
    ds_read_b64 v[10:11], v139
    ds_read_b128 v[48:51], v137 offset:0
    ds_read_b128 v[64:67], v138 offset:0
    ds_read_b128 v[52:55], v137 offset:1024
    ds_read_b128 v[68:71], v138 offset:1024
    ds_read_b128 v[56:59], v137 offset:2048
    ds_read_b128 v[72:75], v138 offset:4096
    ds_read_b128 v[60:63], v137 offset:3072
    ds_read_b128 v[76:79], v138 offset:5120
    s_waitcnt lgkmcnt(6)
    v_pk_add_f32 v[16:17], v[16:17], v[48:49]
    v_pk_add_f32 v[18:19], v[18:19], v[50:51]
    v_pk_fma_f32 v[64:65], v[16:17], v[10:11], v[64:65] op_sel:[0,0,0] op_sel_hi:[1,0,1]
    v_pk_fma_f32 v[66:67], v[18:19], v[10:11], v[66:67] op_sel:[0,0,0] op_sel_hi:[1,0,1]
    v_cvt_pk_bf16_f32 v80, v64, v65
    v_cvt_pk_bf16_f32 v81, v66, v67
    ds_write_b64 v140, v[80:81] offset:0
    s_waitcnt lgkmcnt(5)
    v_pk_add_f32 v[20:21], v[20:21], v[52:53]
    v_pk_add_f32 v[22:23], v[22:23], v[54:55]
    v_pk_fma_f32 v[68:69], v[20:21], v[10:11], v[68:69] op_sel:[0,1,0] op_sel_hi:[1,1,1]
    v_pk_fma_f32 v[70:71], v[22:23], v[10:11], v[70:71] op_sel:[0,1,0] op_sel_hi:[1,1,1]
    v_cvt_pk_bf16_f32 v82, v68, v69
    v_cvt_pk_bf16_f32 v83, v70, v71
    ds_write_b64 v140, v[82:83] offset:1280
    s_waitcnt lgkmcnt(4)
    v_pk_add_f32 v[24:25], v[24:25], v[56:57]
    v_pk_add_f32 v[26:27], v[26:27], v[58:59]
    v_pk_fma_f32 v[72:73], v[24:25], v[10:11], v[72:73] op_sel:[0,0,0] op_sel_hi:[1,0,1]
    v_pk_fma_f32 v[74:75], v[26:27], v[10:11], v[74:75] op_sel:[0,0,0] op_sel_hi:[1,0,1]
    v_cvt_pk_bf16_f32 v84, v72, v73
    v_cvt_pk_bf16_f32 v85, v74, v75
    ds_write_b64 v140, v[84:85] offset:32
    s_waitcnt lgkmcnt(3)
    v_pk_add_f32 v[28:29], v[28:29], v[60:61]
    v_pk_add_f32 v[30:31], v[30:31], v[62:63]
    v_pk_fma_f32 v[76:77], v[28:29], v[10:11], v[76:77] op_sel:[0,1,0] op_sel_hi:[1,1,1]
    v_pk_fma_f32 v[78:79], v[30:31], v[10:11], v[78:79] op_sel:[0,1,0] op_sel_hi:[1,1,1]
    v_cvt_pk_bf16_f32 v86, v76, v77
    v_cvt_pk_bf16_f32 v87, v78, v79
    ds_write_b64 v140, v[86:87] offset:1312
    ds_read_b128 v[88:91], v141
    ds_read_b128 v[92:95], v141 offset:1280
    s_waitcnt lgkmcnt(1)
    buffer_store_dwordx4 v[88:91], v142, s[4:7], s96 offen sc1
    s_waitcnt lgkmcnt(0)
    buffer_store_dwordx4 v[92:95], v142, s[4:7], s97 offen sc1
    s_endpgm
L_g2_pp_48:
L_g2_pw_62:
    ds_read_b32 v10, v11 offset:0
    s_add_u32 s66, s66, 0x1000
    s_cbranch_scc1 L_end
    s_waitcnt lgkmcnt(0)
    v_cmp_gt_u32 vcc, 10, v10
    s_cbranch_vccnz L_g2_pw_62
    s_branch L_g2_pr_49
L_g2_pp_50:
L_g2_pw_64:
    ds_read_b32 v10, v11 offset:0
    s_add_u32 s66, s66, 0x1000
    s_cbranch_scc1 L_end
    s_waitcnt lgkmcnt(0)
    v_cmp_gt_u32 vcc, 11, v10
    s_cbranch_vccnz L_g2_pw_64
    s_branch L_g2_pr_51
L_g2_pp_52:
L_g2_pw_66:
    ds_read_b32 v10, v11 offset:0
    s_add_u32 s66, s66, 0x1000
    s_cbranch_scc1 L_end
    s_waitcnt lgkmcnt(0)
    v_cmp_gt_u32 vcc, 12, v10
    s_cbranch_vccnz L_g2_pw_66
    s_branch L_g2_pr_53
L_g2_pp_54:
L_g2_pw_68:
    ds_read_b32 v10, v11 offset:0
    s_add_u32 s66, s66, 0x1000
    s_cbranch_scc1 L_end
    s_waitcnt lgkmcnt(0)
    v_cmp_gt_u32 vcc, 13, v10
    s_cbranch_vccnz L_g2_pw_68
    s_branch L_g2_pr_55
L_g2_pp_56:
L_g2_pw_70:
    ds_read_b32 v10, v11 offset:0
    s_add_u32 s66, s66, 0x1000
    s_cbranch_scc1 L_end
    s_waitcnt lgkmcnt(0)
    v_cmp_gt_u32 vcc, 14, v10
    s_cbranch_vccnz L_g2_pw_70
    s_branch L_g2_pr_57
L_g2_pp_58:
L_g2_pw_72:
    ds_read_b32 v10, v11 offset:0
    s_add_u32 s66, s66, 0x1000
    s_cbranch_scc1 L_end
    s_waitcnt lgkmcnt(0)
    v_cmp_gt_u32 vcc, 15, v10
    s_cbranch_vccnz L_g2_pw_72
    s_branch L_g2_pr_59
L_end:
    s_endpgm
.p2align 6
L_tab:
.long 0, 1, 2, 3, 4, 5, 6, 7, 8, 9, 10, 11, 12, 13, 14, 15
L_codeend:
.fill (33024-(L_codeend-gated_mix__ssm_conv_s4__dense_activation_squared_relu__prompt_kernel))/4, 4, 0xbf800000
.section .rodata,"a"
.p2align 6
.amdhsa_kernel gated_mix__ssm_conv_s4__dense_activation_squared_relu__prompt_kernel
  .amdhsa_next_free_vgpr 168
  .amdhsa_next_free_sgpr 102
  .amdhsa_accum_offset 168
  .amdhsa_group_segment_fixed_size 0
  .amdhsa_kernarg_size 144
  .amdhsa_user_sgpr_count 2
  .amdhsa_user_sgpr_kernarg_segment_ptr 1
  .amdhsa_system_sgpr_workgroup_id_x 1
.end_amdhsa_kernel
```
